```python
import torch

def _softmax(x, axis=-1):
    return torch.softmax(x, dim=axis)

def _gelu(x):
    return torch.nn.functional.gelu(x, approximate='tanh')

def _silu(x):
    return torch.nn.functional.silu(x)

def _sigmoid(x):
    return torch.sigmoid(x)

def _layernorm(x, axis=-1, eps=1e-05):
    m = x.mean(dim=axis, keepdim=True)
    v = x.var(dim=axis, keepdim=True, unbiased=False)
    return (x - m) / torch.sqrt(v + eps)

def _scatter_add(tgt, idx, src, axis=0):
    return tgt.clone().index_add_(axis, idx, src)

def _segment_sum(src, seg, n):
    out = torch.zeros((n,) + src.shape[1:], dtype=src.dtype)
    return out.index_add_(0, seg, src)

def _pad(x, pw):
    flat = tuple((v for pair in reversed(pw) for v in pair))
    return torch.nn.functional.pad(x, flat)
kernel_name = 'adaLN_cond__sliding_block_cached__dense_activation_silu__decode'

def setup_inputs():

    _w = lambda a: (lambda t: t.to(torch.bfloat16) if t.is_floating_point() else t)(torch.as_tensor(a))

    def _A_setup():
        B, Sq, D = (2, 1, 512)
        Hq, Hkv, Sk, Dh = (32, 8, 32768, 128)
        assert Hq % Hkv == 0, (Hq, Hkv)
        return {'x': _w((lambda *s: torch.randn(*s, dtype=torch.bfloat16) * 0.1)(B, Sq, D)), 'k_cache': _w((lambda *s: torch.randn(*s, dtype=torch.bfloat16) * 0.8)(B, Hkv, Sk, Dh)), 'v_cache': _w((lambda *s: torch.randn(*s, dtype=torch.bfloat16) * 3.2)(B, Hkv, Sk, Dh)), 'wq': _w((lambda *s: torch.randn(*s, dtype=torch.bfloat16) * 0.8)(D, Hq * Dh) * D ** (-0.5)), 'wo': _w((lambda *s: torch.randn(*s, dtype=torch.bfloat16) * 3.2)(Hq * Dh, D) * (Hq * Dh) ** (-0.5))}
    _A_in = _A_setup()

    def _B_setup():
        B, S, D, F = (2, 1, 512, 1792)
        return {'x': _w((lambda *s: torch.randn(*s, dtype=torch.bfloat16) * 0.1)(B, S, D)), 'w1': _w((lambda *s: torch.randn(*s, dtype=torch.bfloat16) * 3.2)(D, F) * D ** (-0.5)), 'w2': _w((lambda *s: torch.randn(*s, dtype=torch.bfloat16) * 3.2)(F, D) * F ** (-0.5))}
    _B_in = _B_setup()
    return {'A_x': _A_in['x'], 'A_k_cache': _A_in['k_cache'], 'A_v_cache': _A_in['v_cache'], 'A_wq': _A_in['wq'], 'A_wo': _A_in['wo'], 'B_x': _B_in['x'], 'B_w1': _B_in['w1'], 'B_w2': _B_in['w2'], 'c': _w((lambda *s: torch.randn(*s, dtype=torch.bfloat16) * 0.2)(2, 512) * 8.0), 'w_mod': _w((lambda *s: torch.randn(*s, dtype=torch.bfloat16) * 0.2)(512, 6 * 512) * 512 ** (-0.5) * 8.0)}

def reference(A_x, A_k_cache, A_v_cache, A_wq, A_wo, B_x, B_w1, B_w2, c, w_mod):

    def _A_ref(x, k_cache, v_cache, wq, wo):
        B, Sq, D = x.shape
        Hq, Dh = (32, 128)
        Hkv, Sk = (k_cache.shape[1], k_cache.shape[2])
        W = min(4096, max(256, Sk // 4))
        rep = Hq // Hkv
        q = (lambda x, *d: x.permute(*d))((x @ wq).reshape(B, Sq, Hq, Dh), 0, 2, 1, 3)
        k = (lambda x, n, axis: torch.repeat_interleave(x, n, dim=axis))(k_cache[:, :, Sk - W:, :], rep, axis=1)
        v = (lambda x, n, axis: torch.repeat_interleave(x, n, dim=axis))(v_cache[:, :, Sk - W:, :], rep, axis=1)
        scores = torch.einsum('bhqd,bhkd->bhqk', q, k) * Dh ** (-0.5)
        p = _softmax(scores, axis=-1)
        o = torch.einsum('bhqk,bhkd->bhqd', p, v)
        return (lambda x, *d: x.permute(*d))(o, 0, 2, 1, 3).reshape(B, Sq, Hq * Dh) @ wo

    def _B_ref(x, w1, w2):
        h = torch.einsum('bsd,df->bsf', x, w1)
        h = _silu(h)
        out = torch.einsum('bsf,fd->bsd', h, w2)
        return out
    x = A_x
    mod = (_silu(c) @ w_mod).reshape(c.shape[0], 6, 1, -1)
    sa, ca, ga, sb, cb, gb = (mod[:, 0].clone(), mod[:, 1].clone(), mod[:, 2].clone(), mod[:, 3].clone(), mod[:, 4].clone(), mod[:, 5].clone())
    h = _layernorm(x, axis=-1) * (1 + ca) + sa
    x = x + ga * _A_ref(h, A_k_cache, A_v_cache, A_wq, A_wo)
    h = _layernorm(x, axis=-1) * (1 + cb) + sb
    x = x + gb * _B_ref(h, B_w1, B_w2)
    return x
```

```asm
; @launch grid=(256,1,1) block=(384,1,1) lds=163840
.amdgcn_target "amdgcn-amd-amdhsa--gfx950"
.text
.globl adaLN_cond__sliding_block_cached__dense_activation_silu__decode_kernel
.p2align 8
.type adaLN_cond__sliding_block_cached__dense_activation_silu__decode_kernel,@function
adaLN_cond__sliding_block_cached__dense_activation_silu__decode_kernel:
    s_load_dwordx16 s[4:19], s[0:1], 0
    s_load_dwordx8 s[20:27], s[0:1], 64
    s_load_dwordx2 s[28:29], s[0:1], 96
    v_lshrrev_b32 v1, 6, v0
    s_cmp_ge_u32 s2, 256
    s_cbranch_scc1 L_end
    v_and_b32 v0, 63, v0
    v_readfirstlane_b32 s3, v1
    s_and_b32 s32, s2, 7
    s_lshr_b32 s33, s2, 3
    s_lshl_b32 s43, s32, 3
    s_add_u32 s42, s43, s33
    s_add_u32 s43, s43, s42
    s_add_u32 s42, s42, 0x70
    s_cmp_lt_u32 s33, 24
    s_cselect_b32 s52, s42, -1
    s_cmp_lt_u32 s33, 16
    s_cselect_b32 s52, s43, s52
    v_mov_b32 v15, 147456
    s_cmp_eq_u32 s3, 4
    s_cbranch_scc1 L_loader
    s_barrier
    s_cmp_eq_u32 s3, 5
    s_cbranch_scc0 L_nopf
    s_getpc_b64 s[42:43]
L_pc:
    s_lshl_b32 s44, s33, 9
    v_lshl_add_u32 v1, v0, 4, s44
    v_min_u32 v1, L_codeend-L_pc-16, v1
    s_mov_b32 exec_hi, 0
    global_load_dwordx4 v[40:43], v1, s[42:43]
    s_mov_b64 exec, -1
    s_branch L_tramp
L_nopf:
    v_lshlrev_b32 v6, 5, v0
    v_and_b32 v6, 0x400, v6
    v_and_b32 v4, 31, v0
    v_lshl_add_u32 v6, v4, 3, v6
    s_and_b32 s42, s52, 3
    v_lshl_add_u32 v6, s42, 8, v6
    s_waitcnt lgkmcnt(0)
    global_load_dwordx2 v[24:25], v6, s[20:21]
    s_branch L_tramp
L_loader:
    s_setprio 3
    v_lshl_add_u32 v1, v0, 2, v15
    v_mov_b32 v2, 0
    s_mov_b64 exec, 0xffff
    ds_write_b32 v1, v2
    s_mov_b64 exec, -1
    v_lshrrev_b32 v4, 3, v0
    v_and_b32 v5, 7, v0
    v_and_b32 v6, 6, v4
    v_xor_b32 v5, v5, v6
    v_lshlrev_b32 v5, 4, v5
    v_mul_u32_u24 v16, 6144, v4
    v_add_u32 v16, v16, v5
    v_mov_b32 v17, v16
    v_mov_b32 v18, v16
    v_mov_b32 v19, v16
    s_and_b32 s42, s52, 3
    s_mul_i32 s42, s42, 786432
    s_lshr_b32 s43, s52, 2
    s_lshl_b32 s43, s43, 7
    s_add_u32 s44, s42, s43
    s_movk_i32 s49, 0x400
    s_mov_b32 s48, -1
    v_mov_b32 v7, 0
    s_mov_b32 s62, 64
    s_mov_b32 s47, 49152
    s_mov_b32 m0, 131072
    s_mov_b32 s58, 3145728
    s_mov_b32 s59, 0x20000
    s_cmp_lt_i32 s52, 0
    s_cselect_b32 s42, -8, -24
    v_mov_b32 v14, s42
    s_cselect_b32 s41, 0, 1
    s_cmp_lt_u32 s33, 16
    s_cselect_b32 s41, 2, s41
    s_cmp_lt_i32 s52, 0
    s_waitcnt lgkmcnt(0)
    s_barrier
    s_mov_b32 s56, s22
    s_mov_b32 s57, s23
    s_cbranch_scc1 L_nomod
    s_mov_b32 s45, 1
    s_call_b64 s[50:51], L_seg
    s_branch L_nomod
L_seg:
    s_waitcnt lgkmcnt(0)
    v_readfirstlane_b32 s42, v7
    ds_read_b32 v7, v15 offset:16
    s_cmp_ge_i32 s42, s62
    s_cbranch_scc1 L_segb
    s_cmp_eq_u32 s41, 0
    s_cbranch_scc1 L_segc0
    s_cmp_eq_u32 s41, 1
    s_cbranch_scc1 L_segc1
L_segc2:
    s_waitcnt vmcnt(20)
    buffer_load_dwordx4 v16, s[56:59], s44 offen nt lds
    s_add_u32 m0, m0, s49
    s_add_u32 s44, s44, s47
    s_and_b32 s44, s44, s48
    s_waitcnt vmcnt(20)
    buffer_load_dwordx4 v17, s[56:59], s44 offen nt lds
    s_add_u32 m0, m0, s49
    s_add_u32 s44, s44, s47
    s_and_b32 s44, s44, s48
    s_waitcnt vmcnt(20)
    buffer_load_dwordx4 v18, s[56:59], s44 offen nt lds
    s_add_u32 m0, m0, s49
    s_add_u32 s44, s44, s47
    s_and_b32 s44, s44, s48
    s_waitcnt vmcnt(20)
    buffer_load_dwordx4 v19, s[56:59], s44 offen nt lds
    s_add_u32 m0, m0, s49
    s_add_u32 s44, s44, s47
    s_and_b32 s44, s44, s48
    s_waitcnt vmcnt(20)
    s_mov_b64 exec, 1
    v_add_u32 v14, 8, v14
    ds_write_b32 v15, v14 offset:0
    s_mov_b64 exec, -1
    buffer_load_dwordx4 v16, s[56:59], s44 offen nt lds
    s_add_u32 m0, m0, s49
    s_add_u32 s44, s44, s47
    s_and_b32 s44, s44, s48
    s_waitcnt vmcnt(20)
    buffer_load_dwordx4 v17, s[56:59], s44 offen nt lds
    s_add_u32 m0, m0, s49
    s_add_u32 s44, s44, s47
    s_and_b32 s44, s44, s48
    s_waitcnt vmcnt(20)
    buffer_load_dwordx4 v18, s[56:59], s44 offen nt lds
    s_add_u32 m0, m0, s49
    s_add_u32 s44, s44, s47
    s_and_b32 s44, s44, s48
    s_waitcnt vmcnt(20)
    buffer_load_dwordx4 v19, s[56:59], s44 offen nt lds
    s_add_u32 m0, m0, s49
    s_add_u32 s44, s44, s47
    s_and_b32 s44, s44, s48
    s_sub_u32 s45, s45, 1
    s_cbranch_scc0 L_seg
    s_setpc_b64 s[50:51]
L_segc1:
    s_waitcnt vmcnt(18)
    buffer_load_dwordx4 v16, s[56:59], s44 offen nt lds
    s_add_u32 m0, m0, s49
    s_add_u32 s44, s44, s47
    s_and_b32 s44, s44, s48
    s_waitcnt vmcnt(18)
    buffer_load_dwordx4 v17, s[56:59], s44 offen nt lds
    s_add_u32 m0, m0, s49
    s_add_u32 s44, s44, s47
    s_and_b32 s44, s44, s48
    s_waitcnt vmcnt(18)
    s_mov_b64 exec, 1
    v_add_u32 v14, 8, v14
    ds_write_b32 v15, v14 offset:0
    s_mov_b64 exec, -1
    buffer_load_dwordx4 v18, s[56:59], s44 offen nt lds
    s_add_u32 m0, m0, s49
    s_add_u32 s44, s44, s47
    s_and_b32 s44, s44, s48
    s_waitcnt vmcnt(18)
    buffer_load_dwordx4 v19, s[56:59], s44 offen nt lds
    s_add_u32 m0, m0, s49
    s_add_u32 s44, s44, s47
    s_and_b32 s44, s44, s48
    s_waitcnt vmcnt(18)
    buffer_load_dwordx4 v16, s[56:59], s44 offen nt lds
    s_add_u32 m0, m0, s49
    s_add_u32 s44, s44, s47
    s_and_b32 s44, s44, s48
    s_waitcnt vmcnt(18)
    buffer_load_dwordx4 v17, s[56:59], s44 offen nt lds
    s_add_u32 m0, m0, s49
    s_add_u32 s44, s44, s47
    s_and_b32 s44, s44, s48
    s_waitcnt vmcnt(18)
    buffer_load_dwordx4 v18, s[56:59], s44 offen nt lds
    s_add_u32 m0, m0, s49
    s_add_u32 s44, s44, s47
    s_and_b32 s44, s44, s48
    s_waitcnt vmcnt(18)
    buffer_load_dwordx4 v19, s[56:59], s44 offen nt lds
    s_add_u32 m0, m0, s49
    s_add_u32 s44, s44, s47
    s_and_b32 s44, s44, s48
    s_sub_u32 s45, s45, 1
    s_cbranch_scc0 L_seg
    s_setpc_b64 s[50:51]
L_tramp:
    s_branch L_others
L_segc0:
    s_waitcnt vmcnt(17)
    buffer_load_dwordx4 v16, s[56:59], s44 offen nt lds
    s_add_u32 m0, m0, s49
    s_add_u32 s44, s44, s47
    s_and_b32 s44, s44, s48
    s_waitcnt vmcnt(17)
    s_mov_b64 exec, 1
    v_add_u32 v14, 8, v14
    ds_write_b32 v15, v14 offset:0
    s_mov_b64 exec, -1
    buffer_load_dwordx4 v17, s[56:59], s44 offen nt lds
    s_add_u32 m0, m0, s49
    s_add_u32 s44, s44, s47
    s_and_b32 s44, s44, s48
    s_waitcnt vmcnt(17)
    buffer_load_dwordx4 v18, s[56:59], s44 offen nt lds
    s_add_u32 m0, m0, s49
    s_add_u32 s44, s44, s47
    s_and_b32 s44, s44, s48
    s_waitcnt vmcnt(17)
    buffer_load_dwordx4 v19, s[56:59], s44 offen nt lds
    s_add_u32 m0, m0, s49
    s_add_u32 s44, s44, s47
    s_and_b32 s44, s44, s48
    s_waitcnt vmcnt(17)
    buffer_load_dwordx4 v16, s[56:59], s44 offen nt lds
    s_add_u32 m0, m0, s49
    s_add_u32 s44, s44, s47
    s_and_b32 s44, s44, s48
    s_waitcnt vmcnt(17)
    buffer_load_dwordx4 v17, s[56:59], s44 offen nt lds
    s_add_u32 m0, m0, s49
    s_add_u32 s44, s44, s47
    s_and_b32 s44, s44, s48
    s_waitcnt vmcnt(17)
    buffer_load_dwordx4 v18, s[56:59], s44 offen nt lds
    s_add_u32 m0, m0, s49
    s_add_u32 s44, s44, s47
    s_and_b32 s44, s44, s48
    s_waitcnt vmcnt(17)
    buffer_load_dwordx4 v19, s[56:59], s44 offen nt lds
    s_add_u32 m0, m0, s49
    s_add_u32 s44, s44, s47
    s_and_b32 s44, s44, s48
    s_sub_u32 s45, s45, 1
    s_cbranch_scc0 L_seg
    s_setpc_b64 s[50:51]
L_nomod:
    v_lshl_add_u32 v16, v4, 13, v5
    s_mov_b32 s56, s10
    s_mov_b32 s57, s11
    s_mov_b32 s58, 4194304
    v_mov_b32 v17, v16
    v_mov_b32 v18, v16
    v_mov_b32 v19, v16
    s_lshr_b32 s42, s33, 3
    s_lshl_b32 s42, s42, 20
    s_and_b32 s43, s33, 7
    s_lshl_b32 s43, s43, 7
    s_add_u32 s42, s42, s43
    s_lshl_b32 s43, s32, 10
    s_add_u32 s44, s42, s43
    s_mov_b32 s47, 0x10000
    s_mov_b32 m0, 0
    s_mov_b32 s45, 1
    s_call_b64 s[50:51], L_seg
    v_lshrrev_b32 v1, 4, v0
    v_and_b32 v2, 15, v0
    v_xor_b32 v3, v2, v1
    v_lshlrev_b32 v3, 4, v3
    v_lshl_add_u32 v16, v1, 8, v3
    v_xor_b32 v17, 64, v16
    v_xor_b32 v18, 128, v16
    v_xor_b32 v19, 192, v16
    s_lshr_b32 s42, s33, 4
    s_lshl_b32 s42, s42, 3
    s_add_u32 s42, s42, s32
    s_lshl_b32 s42, s42, 7
    s_and_b32 s43, s33, 15
    s_add_u32 s42, s42, s43
    s_add_u32 s42, s42, 0x70
    s_lshl_b32 s46, s42, 16
    s_add_u32 s56, s6, s46
    s_addc_u32 s57, s7, 0
    s_mov_b32 s58, 0x10000
    s_mul_i32 s42, s33, 2
    s_mul_i32 s43, s32, 8
    s_add_u32 s42, s42, s43
    s_lshl_b32 s42, s42, 10
    s_mov_b32 s48, 0xffff
    s_and_b32 s44, s42, s48
    s_mov_b32 s47, s49
    s_mov_b32 s45, 7
    s_call_b64 s[50:51], L_seg
    v_lshlrev_b32 v3, 1, v1
    v_xor_b32 v3, v2, v3
    v_lshlrev_b32 v3, 4, v3
    v_lshl_add_u32 v16, v1, 8, v3
    v_xor_b32 v17, 0x80, v16
    v_mov_b32 v18, v16
    v_mov_b32 v19, v17
    s_add_u32 s56, s8, s46
    s_addc_u32 s57, s9, 0
    s_mov_b32 s62, 4
    s_mov_b32 s45, 5
    s_call_b64 s[50:51], L_seg
    s_mov_b32 s40, s44
    s_and_b32 s54, s33, 3
    s_lshr_b32 s44, s33, 2
    s_lshl_b32 s42, s32, 2
    s_add_u32 s53, s42, s44
    s_mov_b32 s55, 0
    s_cmp_lt_u32 s33, 16
    s_cbranch_scc1 Lrole_1
    s_mov_b32 s55, 1
    s_sub_u32 s53, s53, 4
    s_cmp_lt_u32 s32, 4
    s_cbranch_scc1 Lrole_1
    s_mul_i32 s42, s32, 3
    s_add_u32 s53, s42, s44
    s_cmp_lt_u32 s33, 28
    s_cselect_b32 s55, 1, 2
Lrole_1:
    s_mov_b32 s44, s40
    v_lshl_add_u32 v24, v1, 10, v3
    v_xor_b32 v25, 0x80, v24
    s_cmp_lt_i32 s52, 0
    s_cbranch_scc1 L_vtail
    s_mov_b32 s35, 0
Lsp_3:
    ds_read_b32 v9, v15 offset:4
    s_add_u32 s35, s35, 1
    s_cmp_lt_u32 s35, 2000000
    s_cbranch_scc0 L_end
    s_waitcnt lgkmcnt(0)
    v_readfirstlane_b32 s42, v9
    s_cmp_ge_i32 s42, 4
    s_cbranch_scc0 Lsp_3
Lok_2:
L_vtail:
    s_mov_b32 s45, 1
    s_call_b64 s[50:51], L_seg
    s_branch L_loader2
L_others:
    s_mov_b32 s38, 4194304
    s_mov_b32 s39, 0x20000
    s_mov_b32 s34, 0xffffff00
    v_mov_b32 v16, 1
    s_and_b32 s54, s33, 3
    s_lshr_b32 s44, s33, 2
    s_lshl_b32 s42, s32, 2
    s_add_u32 s53, s42, s44
    s_mov_b32 s55, 0
    s_cmp_lt_u32 s33, 16
    s_cbranch_scc1 Lrole_4
    s_mov_b32 s55, 1
    s_sub_u32 s53, s53, 4
    s_cmp_lt_u32 s32, 4
    s_cbranch_scc1 Lrole_4
    s_mul_i32 s42, s32, 3
    s_add_u32 s53, s42, s44
    s_cmp_lt_u32 s33, 28
    s_cselect_b32 s55, 1, 2
Lrole_4:
    s_cmp_eq_u32 s3, 5
    s_cbranch_scc0 L_compute
    v_and_b32 v1, 7, v0
    v_lshlrev_b32 v1, 5, v1
    v_bfe_u32 v2, v0, 3, 1
    v_lshl_add_u32 v2, v2, 13, v1
    s_lshl_b32 s42, s32, 14
    s_and_b32 s43, s33, 7
    s_lshl_b32 s43, s43, 10
    s_add_u32 s42, s42, s43
    s_lshr_b32 s43, s33, 3
    s_lshl_b32 s43, s43, 8
    s_add_u32 s42, s42, s43
    s_add_u32 s42, s42, 131072
    v_lshlrev_b32 v1, 5, v0
    s_lshl_b32 s43, s52, 9
    s_add_u32 s43, s43, 8192
    s_cmp_lt_i32 s52, 0
    s_cselect_b32 s43, 0x400000, s43
    s_mov_b64 exec, 0xffff
    s_waitcnt lgkmcnt(0)
    s_load_dword s30, s[28:29], 0
    s_mov_b32 s36, s28
    s_mov_b32 s37, s29
    buffer_load_dwordx4 v[44:47], v1, s[36:39], s43 offen sc1
    buffer_load_dwordx4 v[48:51], v2, s[36:39], s42 offen sc1
    s_mov_b64 exec, -1
    s_branch L_aux
L_compute:
    v_lshrrev_b32 v1, 4, v0
    v_bfe_u32 v2, v0, 3, 1
    v_and_b32 v3, 7, v0
    v_lshl_add_u32 v4, v1, 3, v3
    v_lshlrev_b32 v4, 5, v4
    v_lshl_add_u32 v4, v2, 10, v4
    v_lshl_add_u32 v5, v3, 2, v1
    s_lshl_b32 s42, s3, 5
    v_add_u32 v5, s42, v5
    v_lshl_add_u32 v5, v2, 9, v5
    v_lshlrev_b32 v148, 1, v5
    s_lshr_b32 s50, s33, 3
    v_lshl_add_u32 v5, s50, 8, v148
    v_lshl_add_u32 v148, s54, 8, v148
    s_waitcnt lgkmcnt(0)
    s_load_dword s30, s[28:29], 0
    s_mov_b32 s36, s28
    s_mov_b32 s37, s29
    global_load_dwordx4 v[64:67], v4, s[4:5]
    global_load_dwordx4 v[68:71], v4, s[4:5] offset:16
    global_load_ushort v18, v5, s[4:5]
    global_load_ushort v19, v148, s[4:5]
    v_lshlrev_b32 v150, 4, v1
    v_and_b32 v4, 1, v0
    v_lshl_add_u32 v151, v4, 6, v150
    v_mul_u32_u24 v4, 320, v4
    v_add3_u32 v10, v4, v150, v15
    v_bfe_u32 v4, v0, 2, 2
    v_lshl_add_u32 v5, v1, 2, v4
    v_bfe_u32 v6, v0, 1, 1
    v_and_b32 v8, 1, v0
    v_lshlrev_b32 v8, 3, v8
    s_lshl_b32 s42, s3, 1
    v_add_u32 v9, s42, v6
    v_and_b32 v12, 6, v5
    v_xor_b32 v9, v9, v12
    v_lshl_add_u32 v9, v9, 4, v8
    v_lshl_add_u32 v12, v5, 7, v9
    s_lshl_b32 s42, s3, 2
    v_add_u32 v9, s42, v6
    v_and_b32 v13, 7, v5
    v_lshlrev_b32 v13, 1, v13
    v_xor_b32 v9, v9, v13
    v_lshl_add_u32 v9, v9, 4, v8
    v_lshl_add_u32 v13, v5, 8, v9
    v_xor_b32 v14, 32, v13
    s_mov_b32 s40, 0
    s_cmp_lt_i32 s52, 0
    s_cbranch_scc1 L_c_nomod
    v_lshrrev_b32 v4, 5, v0
    v_mul_u32_u24 v4, 320, v4
    v_bfe_u32 v5, v0, 3, 2
    v_lshl_add_u32 v4, v5, 6, v4
    v_and_b32 v5, 3, v0
    v_lshl_add_u32 v4, v5, 4, v4
    v_bfe_u32 v5, v0, 2, 1
    v_lshl_add_u32 v4, v5, 3, v4
    s_mul_i32 s42, s3, 640
    s_add_u32 s43, s42, 147968
    v_add_u32 v4, s43, v4
    v_add_u32 v5, s42, v10
    s_waitcnt vmcnt(4)
    v_lshlrev_b32 v26, 16, v24
    v_and_b32 v27, 0xffff0000, v24
    v_lshlrev_b32 v28, 16, v25
    v_and_b32 v29, 0xffff0000, v25
    v_mul_f32 v32, 0xbfb8aa3b, v26
    v_mul_f32 v33, 0xbfb8aa3b, v27
    v_mul_f32 v34, 0xbfb8aa3b, v28
    v_mul_f32 v35, 0xbfb8aa3b, v29
    v_exp_f32 v32, v32
    v_exp_f32 v33, v33
    v_exp_f32 v34, v34
    v_exp_f32 v35, v35
    v_add_f32 v32, 1.0, v32
    v_add_f32 v33, 1.0, v33
    v_add_f32 v34, 1.0, v34
    v_add_f32 v35, 1.0, v35
    v_rcp_f32 v32, v32
    v_rcp_f32 v33, v33
    v_rcp_f32 v34, v34
    v_rcp_f32 v35, v35
    v_mul_f32 v26, v26, v32
    v_mul_f32 v27, v27, v33
    v_mul_f32 v28, v28, v34
    v_mul_f32 v29, v29, v35
    v_cvt_pk_bf16_f32 v24, v26, v27
    v_cvt_pk_bf16_f32 v25, v28, v29
L_pad0:
    s_cbranch_execz L_pad1
    ds_write_b64 v4, v[24:25]
    ds_read_b128 v[48:51], v5 offset:512
    ds_read_b128 v[52:55], v5 offset:576
    ds_read_b128 v[56:59], v5 offset:640
    ds_read_b128 v[60:63], v5 offset:704
    v_add_u32 v6, 131072, v12
    s_lshl_b32 s44, s52, 9
    s_lshl_b32 s43, s3, 7
    s_add_u32 s44, s44, s43
    s_add_u32 s44, s44, 8192
    s_cmp_ge_i32 s40, 16
    s_cbranch_scc1 Lok_5
    s_mov_b32 s35, 0
Lsp_6:
    ds_read_b32 v9, v15 offset:0
    s_add_u32 s35, s35, 1
    s_cmp_lt_u32 s35, 2000000
    s_cbranch_scc0 L_end
    s_waitcnt lgkmcnt(0)
    v_readfirstlane_b32 s40, v9
    s_cmp_ge_i32 s40, 16
    s_cbranch_scc0 Lsp_6
Lok_5:
    ds_read_b64_tr_b16 v[32:33], v6 offset:0
    ds_read_b64_tr_b16 v[34:35], v6 offset:2048
    ds_read_b64_tr_b16 v[36:37], v6 offset:4096
    ds_read_b64_tr_b16 v[38:39], v6 offset:6144
    ds_read_b64_tr_b16 v[40:41], v6 offset:8192
    ds_read_b64_tr_b16 v[42:43], v6 offset:10240
    ds_read_b64_tr_b16 v[44:45], v6 offset:12288
    ds_read_b64_tr_b16 v[46:47], v6 offset:14336
    s_add_u32 s31, s30, 1
    s_and_b32 s31, s31, 0xff
    v_mov_b32 v17, s31
    s_waitcnt lgkmcnt(6)
    v_mfma_f32_16x16x32_bf16 v[128:131], v[32:35], v[48:51], 0
    s_waitcnt lgkmcnt(4)
    v_mfma_f32_16x16x32_bf16 v[128:131], v[36:39], v[52:55], v[128:131]
    s_waitcnt lgkmcnt(2)
    v_mfma_f32_16x16x32_bf16 v[128:131], v[40:43], v[56:59], v[128:131]
    s_waitcnt lgkmcnt(0)
    v_mfma_f32_16x16x32_bf16 v[128:131], v[44:47], v[60:63], v[128:131]
    s_mov_b64 exec, 1
    ds_add_u32 v15, v16 offset:4
    s_mov_b64 exec, -1
    s_mov_b32 exec_lo, 0x00030003
    s_mov_b32 exec_hi, 0x00030003
    s_nop 2
    v_and_or_b32 v128, v128, s34, v17
    v_and_or_b32 v130, v130, s34, v17
    buffer_store_dwordx4 v[128:131], v151, s[36:39], s44 offen
    s_or_b32 s44, s44, 0x200000
    buffer_store_dwordx4 v[128:131], v151, s[36:39], s44 offen sc1
    s_mov_b64 exec, -1
    s_waitcnt vmcnt(2)
    s_branch L_c_ln
L_c_nomod:
    s_waitcnt vmcnt(0) lgkmcnt(0)
    s_add_u32 s31, s30, 1
    s_and_b32 s31, s31, 0xff
    v_mov_b32 v17, s31
L_c_ln:
    v_lshlrev_b32 v72, 16, v64
    v_and_b32 v73, 0xffff0000, v64
    v_lshlrev_b32 v74, 16, v65
    v_and_b32 v75, 0xffff0000, v65
    v_lshlrev_b32 v76, 16, v66
    v_and_b32 v77, 0xffff0000, v66
    v_lshlrev_b32 v78, 16, v67
    v_and_b32 v79, 0xffff0000, v67
    v_lshlrev_b32 v80, 16, v68
    v_and_b32 v81, 0xffff0000, v68
    v_lshlrev_b32 v82, 16, v69
    v_and_b32 v83, 0xffff0000, v69
    v_lshlrev_b32 v84, 16, v70
    v_and_b32 v85, 0xffff0000, v70
    v_lshlrev_b32 v86, 16, v71
    v_and_b32 v87, 0xffff0000, v71
    v_add_f32 v4, v72, v73
    v_add_f32 v4, v4, v74
    v_add_f32 v4, v4, v75
    v_add_f32 v4, v4, v76
    v_add_f32 v4, v4, v77
    v_add_f32 v4, v4, v78
    v_add_f32 v4, v4, v79
    v_add_f32 v4, v4, v80
    v_add_f32 v4, v4, v81
    v_add_f32 v4, v4, v82
    v_add_f32 v4, v4, v83
    v_add_f32 v4, v4, v84
    v_add_f32 v4, v4, v85
    v_add_f32 v4, v4, v86
    v_add_f32 v4, v4, v87
    s_nop 1
    v_add_f32_dpp v4, v4, v4 quad_perm:[1,0,3,2] row_mask:0xf bank_mask:0xf
    s_nop 1
    v_add_f32_dpp v4, v4, v4 quad_perm:[2,3,0,1] row_mask:0xf bank_mask:0xf
    s_nop 1
    v_add_f32_dpp v4, v4, v4 row_half_mirror row_mask:0xf bank_mask:0xf
    v_mov_b32 v5, v4
    s_nop 1
    v_permlane16_swap_b32 v4, v5
    v_add_f32 v4, v4, v5
    v_mov_b32 v5, v4
    s_nop 1
    v_permlane32_swap_b32 v4, v5
    v_add_f32 v4, v4, v5
    v_mul_f32 v4, 0x3b000000, v4
    v_sub_f32 v72, v72, v4
    v_sub_f32 v73, v73, v4
    v_sub_f32 v74, v74, v4
    v_sub_f32 v75, v75, v4
    v_sub_f32 v76, v76, v4
    v_sub_f32 v77, v77, v4
    v_sub_f32 v78, v78, v4
    v_sub_f32 v79, v79, v4
    v_sub_f32 v80, v80, v4
    v_sub_f32 v81, v81, v4
    v_sub_f32 v82, v82, v4
    v_sub_f32 v83, v83, v4
    v_sub_f32 v84, v84, v4
    v_sub_f32 v85, v85, v4
    v_sub_f32 v86, v86, v4
    v_sub_f32 v87, v87, v4
    v_mul_f32 v6, v72, v72
    v_fmac_f32 v6, v73, v73
    v_fmac_f32 v6, v74, v74
    v_fmac_f32 v6, v75, v75
    v_fmac_f32 v6, v76, v76
    v_fmac_f32 v6, v77, v77
    v_fmac_f32 v6, v78, v78
    v_fmac_f32 v6, v79, v79
    v_fmac_f32 v6, v80, v80
    v_fmac_f32 v6, v81, v81
    v_fmac_f32 v6, v82, v82
    v_fmac_f32 v6, v83, v83
    v_fmac_f32 v6, v84, v84
    v_fmac_f32 v6, v85, v85
    v_fmac_f32 v6, v86, v86
    v_fmac_f32 v6, v87, v87
    s_nop 1
    v_add_f32_dpp v6, v6, v6 quad_perm:[1,0,3,2] row_mask:0xf bank_mask:0xf
    s_nop 1
    v_add_f32_dpp v6, v6, v6 quad_perm:[2,3,0,1] row_mask:0xf bank_mask:0xf
    s_nop 1
    v_add_f32_dpp v6, v6, v6 row_half_mirror row_mask:0xf bank_mask:0xf
    v_mov_b32 v5, v6
    s_nop 1
    v_permlane16_swap_b32 v6, v5
    v_add_f32 v6, v6, v5
    v_mov_b32 v5, v6
    s_nop 1
    v_permlane32_swap_b32 v6, v5
    v_add_f32 v6, v6, v5
    v_mul_f32 v6, 0x3b000000, v6
    v_cvt_pk_bf16_f32 v8, v4, v4
    v_lshlrev_b32 v4, 16, v8
    v_cvt_pk_bf16_f32 v8, v6, v6
    v_lshlrev_b32 v6, 16, v8
    v_add_f32 v6, 0x3727c5ac, v6
    v_cvt_pk_bf16_f32 v8, v6, v6
    v_lshlrev_b32 v6, 16, v8
    v_sqrt_f32 v6, v6
    s_nop 0
    v_cvt_pk_bf16_f32 v8, v6, v6
    v_lshlrev_b32 v6, 16, v8
    v_rcp_f32 v6, v6
    v_lshlrev_b32 v18, 16, v18
    v_lshlrev_b32 v19, 16, v19
    v_sub_f32 v18, v18, v4
    v_cvt_pk_bf16_f32 v8, v18, v18
    v_lshlrev_b32 v18, 16, v8
    v_mul_f32 v18, v18, v6
    v_cvt_pk_bf16_f32 v8, v18, v18
    v_lshlrev_b32 v18, 16, v8
    v_and_b32 v4, 3, v0
    v_lshlrev_b32 v4, 4, v4
    v_bfe_u32 v5, v0, 2, 1
    v_lshl_add_u32 v7, v2, 6, v4
    v_lshl_add_u32 v7, v5, 7, v7
    v_lshl_add_u32 v7, v1, 9, v7
    v_lshl_add_u32 v4, v5, 3, v4
    v_lshl_add_u32 v4, v1, 1, v4
    s_lshl_b32 s42, s3, 6
    s_add_u32 s42, s42, 147456
    v_add_u32 v4, s42, v4
    v_mul_u32_u24 v6, 320, v2
    v_add_u32 v11, v6, v4
    v_mul_u32_u24 v6, 272, v2
    v_add_u32 v149, v6, v4
    v_lshlrev_b32 v152, 4, v0
    v_and_b32 v4, 1, v0
    v_lshl_add_u32 v159, v4, 13, v150
    s_lshl_b32 s42, s32, 14
    s_and_b32 s43, s33, 7
    s_lshl_b32 s43, s43, 10
    s_add_u32 s42, s42, s43
    s_lshl_b32 s43, s50, 8
    s_add_u32 s42, s42, s43
    s_lshl_b32 s43, s3, 6
    s_add_u32 s42, s42, s43
    s_add_u32 s51, s42, 131072
    s_getreg_b32 s42, hwreg(HW_REG_XCC_ID, 0, 4)
    s_lshl_b32 s42, s42, 4
    s_and_b32 s43, s31, 15
    s_or_b32 s101, s42, s43
L_pad1:
    s_cbranch_execz L_pad2
    v_mov_b32 v153, s101
    s_cmp_ge_i32 s40, 32
    s_cbranch_scc1 Lok_7
    s_mov_b32 s35, 0
Lsp_8:
    ds_read_b32 v9, v15 offset:0
    s_add_u32 s35, s35, 1
    s_cmp_lt_u32 s35, 2000000
    s_cbranch_scc0 L_end
    s_waitcnt lgkmcnt(0)
    v_readfirstlane_b32 s40, v9
    s_cmp_ge_i32 s40, 32
    s_cbranch_scc0 Lsp_8
Lok_7:
    ds_read_b64_tr_b16 v[32:33], v12 offset:0
    ds_read_b64_tr_b16 v[34:35], v12 offset:2048
    ds_read_b64_tr_b16 v[36:37], v12 offset:4096
    ds_read_b64_tr_b16 v[38:39], v12 offset:6144
    ds_read_b64_tr_b16 v[40:41], v12 offset:8192
    ds_read_b64_tr_b16 v[42:43], v12 offset:10240
    ds_read_b64_tr_b16 v[44:45], v12 offset:12288
    ds_read_b64_tr_b16 v[46:47], v12 offset:14336
    s_cmp_ge_i32 s40, 48
    s_cbranch_scc1 Lok_9
    s_mov_b32 s35, 0
Lsp_10:
    ds_read_b32 v9, v15 offset:0
    s_add_u32 s35, s35, 1
    s_cmp_lt_u32 s35, 2000000
    s_cbranch_scc0 L_end
    s_waitcnt lgkmcnt(0)
    v_readfirstlane_b32 s40, v9
    s_cmp_ge_i32 s40, 48
    s_cbranch_scc0 Lsp_10
Lok_9:
    s_lshl_b32 s42, s50, 1
    s_lshr_b32 s43, s3, 1
    s_add_u32 s42, s42, s43
    s_lshl_b32 s48, s42, 11
    s_and_b32 s43, s3, 1
    s_lshl_b32 s43, s43, 8
    s_add_u32 s48, s48, s43
    s_lshr_b32 s43, s42, 2
    s_add_u32 s43, s43, 0
    s_cmp_eq_u32 s43, s32
    s_cselect_b32 s43, 0, 1
    s_lshl_b32 s43, s43, 21
    s_add_u32 s43, s43, s48
    s_add_u32 s44, s43, 8192
    s_lshr_b32 s43, s42, 2
    s_add_u32 s43, s43, 2
    s_cmp_eq_u32 s43, s32
    s_cselect_b32 s43, 0, 1
    s_lshl_b32 s43, s43, 21
    s_add_u32 s43, s43, s48
    s_add_u32 s45, s43, 24576
    s_mov_b32 s35, 0
Ltry_11:
    buffer_load_dwordx4 v[96:99], v7, s[36:39], s44 offen offset:0 sc1
    buffer_load_dwordx4 v[100:103], v7, s[36:39], s45 offen offset:0 sc1
    s_add_u32 s35, s35, 1
    s_cmp_lt_u32 s35, 24
    s_cselect_b32 s43, 0, 0x200000
    s_or_b32 s44, s44, s43
    s_or_b32 s45, s45, s43
    s_cmp_lt_u32 s35, 200000
    s_cbranch_scc0 L_end
Lchk_12:
    s_waitcnt vmcnt(1)
    v_xor_b32 v96, s31, v96
    v_xor_b32 v98, s31, v98
    v_or_b32 v9, v96, v98
    s_waitcnt vmcnt(0)
    v_xor_b32 v100, s31, v100
    v_xor_b32 v102, s31, v102
    v_or3_b32 v9, v100, v102, v9
    v_and_b32 v8, 0xff, v9
    v_cmp_ne_u32 vcc, 0, v8
    s_cbranch_vccnz Ltry_11
    v_permlane32_swap_b32 v96, v98
    v_permlane32_swap_b32 v97, v99
    v_permlane32_swap_b32 v100, v102
    v_permlane32_swap_b32 v101, v103
    v_add_f32 v96, v96, v98
    v_add_f32 v97, v97, v99
    v_add_f32 v100, v100, v102
    v_add_f32 v101, v101, v103
    v_permlane16_swap_b32 v96, v97
    s_nop 0
    v_permlane16_swap_b32 v100, v101
    v_add_f32 v4, v96, v97
    v_add_f32 v5, v100, v101
    v_cvt_pk_bf16_f32 v8, v4, v4
    v_lshlrev_b32 v4, 16, v8
    v_cvt_pk_bf16_f32 v8, v5, v5
    v_lshlrev_b32 v5, 16, v8
    v_add_f32 v5, 1.0, v5
    v_cvt_pk_bf16_f32 v8, v5, v5
    v_lshlrev_b32 v5, 16, v8
    v_mul_f32 v5, v18, v5
    v_cvt_pk_bf16_f32 v8, v5, v5
    v_lshlrev_b32 v5, 16, v8
    v_add_f32 v5, v5, v4
    v_cvt_pk_bf16_f32 v5, v5, v5
    ds_write_b16 v11, v5 offset:3072
    s_mov_b64 exec, 1
    ds_add_u32 v15, v16 offset:8
    s_mov_b64 exec, -1
    s_mov_b32 s35, 0
Lsp_14:
    ds_read_b32 v9, v15 offset:8
    s_add_u32 s35, s35, 1
    s_cmp_lt_u32 s35, 2000000
    s_cbranch_scc0 L_end
    s_waitcnt lgkmcnt(0)
    v_readfirstlane_b32 s42, v9
    s_cmp_ge_i32 s42, 4
    s_cbranch_scc0 Lsp_14
Lok_13:
    ds_read_b128 v[48:51], v10 offset:3072
    ds_read_b128 v[52:55], v10 offset:3136
    ds_read_b128 v[56:59], v10 offset:3200
    ds_read_b128 v[60:63], v10 offset:3264
    s_waitcnt lgkmcnt(3)
    v_mfma_f32_16x16x32_bf16 v[140:143], v[32:35], v[48:51], 0
    s_waitcnt lgkmcnt(2)
    v_mfma_f32_16x16x32_bf16 v[140:143], v[36:39], v[52:55], v[140:143]
    s_waitcnt lgkmcnt(1)
    v_mfma_f32_16x16x32_bf16 v[140:143], v[40:43], v[56:59], v[140:143]
    s_waitcnt lgkmcnt(0)
    v_mfma_f32_16x16x32_bf16 v[140:143], v[44:47], v[60:63], v[140:143]
    s_nop 7
    v_and_or_b32 v140, v140, s34, v17
    v_and_or_b32 v142, v142, s34, v153
    s_mov_b32 exec_lo, 0x00030003
    s_mov_b32 exec_hi, 0x00030003
    buffer_store_dwordx4 v[140:143], v159, s[36:39], s51 offen
    s_mov_b64 exec, -1
    s_or_b32 s51, s51, 0x200000
    v_and_b32 v4, 3, v0
    v_lshl_add_u32 v4, v4, 14, v150
    v_bfe_u32 v5, v0, 2, 1
    v_lshl_add_u32 v154, v5, 6, v4
    s_lshl_b32 s42, s32, 4
    s_add_u32 s42, s42, s3
    s_lshl_b32 s42, s42, 5
    s_and_b32 s43, s33, 3
    s_lshl_b32 s43, s43, 3
    s_add_u32 s42, s42, s43
    s_bfe_u32 s43, s33, 0x20002
    s_lshl_b32 s43, s43, 1
    s_add_u32 s42, s42, s43
    s_lshr_b32 s43, s33, 4
    s_add_u32 s42, s42, s43
    s_lshl_b32 s42, s42, 7
    s_add_u32 s96, s42, 1048576
    v_and_b32 v4, 1, v0
    v_bfe_u32 v5, v0, 1, 1
    v_lshl_add_u32 v5, v5, 6, v150
    s_cmp_eq_u32 s55, 0
    s_cbranch_scc0 L_c_nowo
    v_lshl_add_u32 v155, v4, 7, v5
    s_lshl_b32 s42, s54, 2
    s_add_u32 s42, s42, s3
    s_lshl_b32 s42, s42, 5
    s_add_u32 s42, s42, s53
    s_lshl_b32 s42, s42, 8
    s_add_u32 s97, s42, 294912
    s_lshl_b32 s42, s53, 2
    s_add_u32 s42, s42, s3
    s_lshl_b32 s42, s42, 12
    s_add_u32 s99, s42, 1048576
    v_lshlrev_b32 v4, 5, v1
    v_lshl_add_u32 v156, v2, 7, v4
    s_lshr_b32 s42, s42, 4
    s_add_u32 s100, s42, 819200
L_c_nowo:
    s_cmp_eq_u32 s55, 1
    s_cbranch_scc0 L_c_noffn
    s_lshl_b32 s42, s54, 2
    s_add_u32 s42, s42, s3
    s_lshl_b32 s43, s42, 13
    s_add_u32 s99, s43, 294912
    v_and_b32 v4, 15, v0
    v_mul_u32_u24 v5, 272, v4
    v_add3_u32 v157, v5, v150, v15
    v_lshlrev_b32 v5, 1, v2
    v_sub_u32 v4, v4, v5
    v_and_b32 v5, 3, v4
    v_lshl_add_u32 v5, v5, 6, v150
    v_lshrrev_b32 v4, 2, v4
    v_lshl_add_u32 v155, v4, 10, v5
    s_lshl_b32 s42, s53, 2
    s_add_u32 s42, s42, s3
    s_lshl_b32 s42, s42, 11
    s_lshl_b32 s43, s54, 8
    s_add_u32 s42, s42, s43
    s_add_u32 s97, s42, 425984
L_c_noffn:
    v_and_b32 v4, 15, v0
    v_xor_b32 v5, v4, v1
    v_lshlrev_b32 v5, 4, v5
    v_lshl_add_u32 v5, v4, 8, v5
    s_lshl_b32 s42, s3, 14
    s_add_u32 s42, s42, 16384
L_pad2:
    s_cbranch_execz L_pad3
    v_add_u32 v24, s42, v5
    v_xor_b32 v25, 64, v24
    v_xor_b32 v26, 128, v24
    v_xor_b32 v27, 192, v24
    s_lshl_b32 s42, s32, 1
    s_lshr_b32 s43, s33, 4
    s_add_u32 s42, s42, s43
    s_lshl_b32 s42, s42, 13
    s_lshl_b32 s43, s3, 11
    s_add_u32 s42, s42, s43
    s_add_u32 s44, s42, 131072
    s_mov_b32 s45, s44
    s_mov_b32 s56, 0x00f000f0
    s_mov_b32 s57, 0x00f000f0
    s_mov_b32 s58, 0x0f000f00
    s_mov_b32 s59, 0x0f000f00
    s_mov_b32 s60, 0xf000f000
    s_mov_b32 s61, 0xf000f000
    v_and_b32 v4, 15, v0
    v_lshl_add_u32 v4, v4, 2, v1
    v_lshlrev_b32 v4, 1, v4
    s_mul_i32 s42, s3, 320
    s_add_u32 s42, s42, 151168
    v_add_u32 v28, s42, v4
    v_and_b32 v4, 3, v0
    v_mul_u32_u24 v5, 320, v4
    v_add3_u32 v29, v5, v150, v15
    v_mul_u32_u24 v5, 576, v4
    v_add3_u32 v30, v5, v150, v15
    v_bfe_u32 v8, v0, 2, 1
    v_lshl_add_u32 v5, v8, 3, v30
    v_lshl_add_u32 v5, v2, 6, v5
    s_lshl_b32 s42, s3, 7
    v_add_u32 v31, s42, v5
    v_lshl_add_u32 v144, v4, 4, v15
    s_lshl_b32 s42, s3, 2
    v_add_u32 v145, s42, v144
    v_lshlrev_b32 v147, 10, v4
    v_add_u32 v153, v152, v15
    v_add_u32 v146, s42, v153
    s_cmp_ge_i32 s40, 72
    s_cbranch_scc1 Lok_15
    s_mov_b32 s35, 0
Lsp_16:
    ds_read_b32 v9, v15 offset:0
    s_add_u32 s35, s35, 1
    s_cmp_lt_u32 s35, 2000000
    s_cbranch_scc0 L_end
    s_waitcnt lgkmcnt(0)
    v_readfirstlane_b32 s40, v9
    s_cmp_ge_i32 s40, 72
    s_cbranch_scc0 Lsp_16
Lok_15:
    s_mov_b32 s35, 0
    buffer_load_dwordx4 v[160:163], v152, s[36:39], s44 offen offset:0 sc1
    buffer_load_dwordx4 v[164:167], v152, s[36:39], s44 offen offset:1024 sc1
    s_lshl_b32 s43, s3, 4
    s_add_u32 s43, s43, 48
    s_cmp_ge_i32 s40, s43
    s_cbranch_scc1 Lok_21
    s_mov_b32 s35, 0
Lsp_22:
    ds_read_b32 v9, v15 offset:0
    s_add_u32 s35, s35, 1
    s_cmp_lt_u32 s35, 2000000
    s_cbranch_scc0 L_end
    s_waitcnt lgkmcnt(0)
    v_readfirstlane_b32 s40, v9
    s_cmp_ge_i32 s40, s43
    s_cbranch_scc0 Lsp_22
Lok_21:
    ds_read_b128 v[64:67], v24 offset:0
    ds_read_b128 v[68:71], v25 offset:0
    ds_read_b128 v[72:75], v26 offset:0
    ds_read_b128 v[76:79], v27 offset:0
    ds_read_b128 v[80:83], v24 offset:4096
    ds_read_b128 v[84:87], v25 offset:4096
    ds_read_b128 v[88:91], v26 offset:4096
    ds_read_b128 v[92:95], v27 offset:4096
    ds_read_b128 v[96:99], v24 offset:8192
    ds_read_b128 v[100:103], v25 offset:8192
    ds_read_b128 v[104:107], v26 offset:8192
    ds_read_b128 v[108:111], v27 offset:8192
    ds_read_b128 v[112:115], v24 offset:12288
    ds_read_b128 v[116:119], v25 offset:12288
    ds_read_b128 v[120:123], v26 offset:12288
    ds_read_b128 v[124:127], v27 offset:12288
    s_mov_b32 s35, 0
Ltry_17:
    buffer_load_dwordx4 v[168:171], v152, s[36:39], s45 offen offset:0 sc1
    buffer_load_dwordx4 v[172:175], v152, s[36:39], s45 offen offset:1024 sc1
    s_waitcnt vmcnt(3)
    v_xor_b32 v160, s31, v160
    v_xor_b32 v162, s101, v162
    s_waitcnt vmcnt(2)
    v_xor_b32 v164, s31, v164
    v_xor_b32 v166, s101, v166
    v_or_b32 v8, v160, v164
    v_or_b32 v9, v162, v166
    v_and_b32 v8, 0xff, v8
    v_and_or_b32 v8, v9, 15, v8
    v_cmp_ne_u32 vcc, 0, v8
    s_cbranch_vccz Lok_19
    buffer_load_dwordx4 v[160:163], v152, s[36:39], s44 offen offset:0 sc1
    buffer_load_dwordx4 v[164:167], v152, s[36:39], s44 offen offset:1024 sc1
    s_waitcnt vmcnt(3)
    v_xor_b32 v168, s31, v168
    v_xor_b32 v170, s101, v170
    s_waitcnt vmcnt(2)
    v_xor_b32 v172, s31, v172
    v_xor_b32 v174, s101, v174
    v_or_b32 v8, v168, v172
    v_or_b32 v9, v170, v174
    v_and_b32 v8, 0xff, v8
    v_and_or_b32 v8, v9, 15, v8
    v_cmp_ne_u32 vcc, 0, v8
    s_cbranch_vccz Lok_20
    s_add_u32 s35, s35, 1
    s_cmp_lg_u32 s35, 24
    s_cbranch_scc1 Ltry_17_n
    s_or_b32 s45, s45, 0x200000
    s_mov_b32 exec_lo, 0x00030003
    s_mov_b32 exec_hi, 0x00030003
    buffer_store_dwordx4 v[140:143], v159, s[36:39], s51 offen sc1
    s_mov_b64 exec, -1
Ltry_17_n:
    s_cmp_lt_u32 s35, 200000
    s_cbranch_scc1 Ltry_17
    s_endpgm
Lok_20:
    v_and_b32 v168, s34, v168
    v_and_b32 v170, s34, v170
    v_and_b32 v172, s34, v172
    v_and_b32 v174, s34, v174
    v_permlane32_swap_b32 v168, v170
    v_permlane32_swap_b32 v169, v171
    v_permlane32_swap_b32 v172, v174
    v_permlane32_swap_b32 v173, v175
    v_add_f32 v168, v168, v170
    v_add_f32 v169, v169, v171
    v_add_f32 v172, v172, v174
    v_add_f32 v173, v173, v175
    v_permlane16_swap_b32 v168, v169
    s_nop 0
    v_permlane16_swap_b32 v172, v173
    v_add_f32 v4, v168, v169
    v_add_f32 v5, v172, v173
    s_branch Lfin_18
Lok_19:
    v_and_b32 v160, s34, v160
    v_and_b32 v162, s34, v162
    v_and_b32 v164, s34, v164
    v_and_b32 v166, s34, v166
    v_permlane32_swap_b32 v160, v162
    v_permlane32_swap_b32 v161, v163
    v_permlane32_swap_b32 v164, v166
    v_permlane32_swap_b32 v165, v167
    v_add_f32 v160, v160, v162
    v_add_f32 v161, v161, v163
    v_add_f32 v164, v164, v166
    v_add_f32 v165, v165, v167
    v_permlane16_swap_b32 v160, v161
    s_nop 0
    v_permlane16_swap_b32 v164, v165
    v_add_f32 v4, v160, v161
    v_add_f32 v5, v164, v165
Lfin_18:
    v_cvt_pk_bf16_f32 v4, v4, v5
    ds_write_b16 v28, v4
    ds_write_b16_d16_hi v28, v4 offset:128
    v_and_b32 v9, 0xf0, v9
    v_cmp_ne_u32 vcc, 0, v9
    s_cbranch_vccz L_c_same
    ds_write_b32 v15, v16 offset:28
L_c_same:
    s_mov_b64 exec, 1
    ds_add_u32 v15, v16 offset:16
    s_mov_b64 exec, -1
    s_mov_b32 s35, 0
Lsp_24:
    ds_read_b32 v9, v15 offset:16
    s_add_u32 s35, s35, 1
    s_cmp_eq_u32 s35, 256
    s_cbranch_scc1 Lsp_24_h
Lsp_24_n:
    s_cmp_lt_u32 s35, 2000000
    s_cbranch_scc0 L_end
    s_waitcnt lgkmcnt(0)
    v_readfirstlane_b32 s42, v9
    s_cmp_ge_i32 s42, 4
    s_cbranch_scc0 Lsp_24
Lok_23:
    ds_read_b128 v[48:51], v29 offset:3712
    ds_read_b128 v[52:55], v29 offset:3776
    ds_read_b128 v[56:59], v29 offset:3840
    ds_read_b128 v[60:63], v29 offset:3904
    ds_read_b32 v6, v15 offset:28
    ds_read_b32 v9, v15 offset:0
L_pad3:
    s_cbranch_execz L_pad4
    v_add_u32 v24, 81920, v13
    v_add_u32 v25, 81920, v14
    s_waitcnt lgkmcnt(5)
    v_mfma_f32_16x16x32_bf16 v[128:131], v[64:67], v[48:51], 0
    v_mfma_f32_16x16x32_bf16 v[132:135], v[80:83], v[48:51], 0
    v_mfma_f32_16x16x32_bf16 v[136:139], v[96:99], v[48:51], 0
    v_mfma_f32_16x16x32_bf16 v[32:35], v[112:115], v[48:51], 0
    s_waitcnt lgkmcnt(4)
    v_mfma_f32_16x16x32_bf16 v[128:131], v[68:71], v[52:55], v[128:131]
    v_mfma_f32_16x16x32_bf16 v[132:135], v[84:87], v[52:55], v[132:135]
    v_mfma_f32_16x16x32_bf16 v[136:139], v[100:103], v[52:55], v[136:139]
    v_mfma_f32_16x16x32_bf16 v[32:35], v[116:119], v[52:55], v[32:35]
    s_waitcnt lgkmcnt(3)
    v_mfma_f32_16x16x32_bf16 v[128:131], v[72:75], v[56:59], v[128:131]
    v_mfma_f32_16x16x32_bf16 v[132:135], v[88:91], v[56:59], v[132:135]
    v_mfma_f32_16x16x32_bf16 v[136:139], v[104:107], v[56:59], v[136:139]
    v_mfma_f32_16x16x32_bf16 v[32:35], v[120:123], v[56:59], v[32:35]
    s_waitcnt lgkmcnt(2)
    v_mfma_f32_16x16x32_bf16 v[128:131], v[76:79], v[60:63], v[128:131]
    v_mfma_f32_16x16x32_bf16 v[132:135], v[92:95], v[60:63], v[132:135]
    v_mfma_f32_16x16x32_bf16 v[136:139], v[108:111], v[60:63], v[136:139]
    v_mfma_f32_16x16x32_bf16 v[32:35], v[124:127], v[60:63], v[32:35]
    s_waitcnt lgkmcnt(0)
    s_mov_b64 exec, 1
    ds_add_u32 v15, v16 offset:12
    s_mov_b64 exec, -1
    v_readfirstlane_b32 s41, v6
    v_readfirstlane_b32 s40, v9
    s_cmp_eq_u32 s41, 0
    s_cbranch_scc1 L_c_same2
    s_mov_b32 exec_lo, 0x00030003
    s_mov_b32 exec_hi, 0x00030003
    buffer_store_dwordx4 v[140:143], v159, s[36:39], s51 offen sc1
    s_mov_b64 exec, -1
L_c_same2:
    s_cmp_ge_i32 s40, 160
    s_cselect_b32 s49, 1, 0
    s_cbranch_scc0 L_c_vlate
    ds_read_b64_tr_b16 v[64:65], v24 offset:0
    ds_read_b64_tr_b16 v[66:67], v24 offset:4096
    ds_read_b64_tr_b16 v[68:69], v25 offset:0
    ds_read_b64_tr_b16 v[70:71], v25 offset:4096
    ds_read_b64_tr_b16 v[72:73], v24 offset:8192
    ds_read_b64_tr_b16 v[74:75], v24 offset:12288
    ds_read_b64_tr_b16 v[76:77], v25 offset:8192
    ds_read_b64_tr_b16 v[78:79], v25 offset:12288
    ds_read_b64_tr_b16 v[80:81], v24 offset:16384
    ds_read_b64_tr_b16 v[82:83], v24 offset:20480
    ds_read_b64_tr_b16 v[84:85], v25 offset:16384
    ds_read_b64_tr_b16 v[86:87], v25 offset:20480
    ds_read_b64_tr_b16 v[88:89], v24 offset:24576
    ds_read_b64_tr_b16 v[90:91], v24 offset:28672
    ds_read_b64_tr_b16 v[92:93], v25 offset:24576
    ds_read_b64_tr_b16 v[94:95], v25 offset:28672
    ds_read_b64_tr_b16 v[96:97], v24 offset:32768
    ds_read_b64_tr_b16 v[98:99], v24 offset:36864
    ds_read_b64_tr_b16 v[100:101], v25 offset:32768
    ds_read_b64_tr_b16 v[102:103], v25 offset:36864
    ds_read_b64_tr_b16 v[104:105], v24 offset:40960
    ds_read_b64_tr_b16 v[106:107], v24 offset:45056
    ds_read_b64_tr_b16 v[108:109], v25 offset:40960
    ds_read_b64_tr_b16 v[110:111], v25 offset:45056
    ds_read_b64_tr_b16 v[112:113], v24 offset:49152
    ds_read_b64_tr_b16 v[114:115], v24 offset:53248
    ds_read_b64_tr_b16 v[116:117], v25 offset:49152
    ds_read_b64_tr_b16 v[118:119], v25 offset:53248
    ds_read_b64_tr_b16 v[120:121], v24 offset:57344
    ds_read_b64_tr_b16 v[122:123], v24 offset:61440
    ds_read_b64_tr_b16 v[124:125], v25 offset:57344
    ds_read_b64_tr_b16 v[126:127], v25 offset:61440
L_c_vlate:
    v_cndmask_b32 v128, v128, v132, s[56:57]
    v_cndmask_b32 v129, v129, v133, s[56:57]
    v_cndmask_b32 v130, v130, v134, s[56:57]
    v_cndmask_b32 v131, v131, v135, s[56:57]
    v_cndmask_b32 v128, v128, v136, s[58:59]
    v_cndmask_b32 v129, v129, v137, s[58:59]
    v_cndmask_b32 v130, v130, v138, s[58:59]
    v_cndmask_b32 v131, v131, v139, s[58:59]
    v_cndmask_b32 v128, v128, v32, s[60:61]
    v_cndmask_b32 v129, v129, v33, s[60:61]
    v_cndmask_b32 v130, v130, v34, s[60:61]
    v_cndmask_b32 v131, v131, v35, s[60:61]
    v_cvt_pk_bf16_f32 v4, v128, v129
    v_cvt_pk_bf16_f32 v5, v130, v131
    v_lshlrev_b32 v128, 16, v4
    v_and_b32 v129, 0xffff0000, v4
    v_lshlrev_b32 v130, 16, v5
    v_and_b32 v131, 0xffff0000, v5
    v_mul_f32 v128, 0x3db504f3, v128
    v_mul_f32 v129, 0x3db504f3, v129
    v_mul_f32 v130, 0x3db504f3, v130
    v_mul_f32 v131, 0x3db504f3, v131
    v_cvt_pk_bf16_f32 v4, v128, v129
    v_cvt_pk_bf16_f32 v5, v130, v131
    v_lshlrev_b32 v128, 16, v4
    v_and_b32 v129, 0xffff0000, v4
    v_lshlrev_b32 v130, 16, v5
    v_and_b32 v131, 0xffff0000, v5
    v_max3_f32 v4, v128, v129, v130
    v_max_f32 v4, v4, v131
    s_mov_b32 s42, 0x3fb8aa3b
    s_nop 0
    v_max_f32_dpp v4, v4, v4 row_ror:4 row_mask:0xf bank_mask:0xf
    s_nop 1
    v_max_f32_dpp v4, v4, v4 row_ror:8 row_mask:0xf bank_mask:0xf
    v_mov_b32 v5, v4
    s_nop 1
    v_permlane16_swap_b32 v4, v5
    v_max_f32 v4, v4, v5
    v_mov_b32 v5, v4
    s_nop 1
    v_permlane32_swap_b32 v4, v5
    v_max_f32 v4, v4, v5
    v_mul_f32 v5, 0xbfb8aa3b, v4
    v_fma_f32 v128, v128, s42, v5
    v_fma_f32 v129, v129, s42, v5
    v_fma_f32 v130, v130, s42, v5
    v_fma_f32 v131, v131, s42, v5
    v_exp_f32 v128, v128
    v_exp_f32 v129, v129
    v_exp_f32 v130, v130
    v_exp_f32 v131, v131
    s_mov_b64 exec, 15
    ds_write_b32 v145, v4 offset:256
    s_mov_b64 exec, -1
    v_cvt_pk_bf16_f32 v4, v128, v129
    v_cvt_pk_bf16_f32 v5, v130, v131
    ds_write_b64 v31, v[4:5] offset:4992
    v_lshlrev_b32 v128, 16, v4
    v_and_b32 v129, 0xffff0000, v4
    v_lshlrev_b32 v130, 16, v5
    v_and_b32 v131, 0xffff0000, v5
    v_add_f32 v128, v128, v129
    v_add_f32 v130, v130, v131
    v_add_f32 v6, v128, v130
    ds_write_b32 v146, v6 offset:512
    s_mov_b64 exec, 1
    ds_add_u32 v15, v16 offset:24
    s_mov_b64 exec, -1
    s_mov_b32 s35, 0
Lsp_26:
    ds_read_b32 v9, v15 offset:24
    s_add_u32 s35, s35, 1
    s_cmp_lt_u32 s35, 2000000
    s_cbranch_scc0 L_end
    s_waitcnt lgkmcnt(0)
    v_readfirstlane_b32 s42, v9
    s_cmp_ge_i32 s42, 4
    s_cbranch_scc0 Lsp_26
Lok_25:
    ds_read_b128 v[136:139], v144 offset:256
    ds_read_b128 v[184:187], v30 offset:4992
    ds_read_b128 v[188:191], v30 offset:5056
    ds_read_b128 v[192:195], v30 offset:5120
    ds_read_b128 v[196:199], v30 offset:5184
    ds_read_b128 v[200:203], v30 offset:5248
    ds_read_b128 v[204:207], v30 offset:5312
L_pad4:
    s_cbranch_execz L_pad5
    ds_read_b128 v[208:211], v30 offset:5376
    ds_read_b128 v[212:215], v30 offset:5440
    ds_read_b128 v[140:143], v153 offset:512
    s_lshl_b32 s43, s32, 12
    s_lshl_b32 s44, s33, 3
    s_add_u32 s43, s43, s44
    s_lshl_b32 s44, s3, 8
    s_add_u32 s43, s43, s44
    s_add_u32 s44, s43, 819200
    s_add_u32 s46, s30, 1
    s_mul_i32 s46, s46, 0x9e3779b1
    s_mov_b32 s43, 0x3fb8aa3b
    s_cmp_eq_u32 s49, 1
    s_cbranch_scc0 L_c_pvslow
    s_waitcnt lgkmcnt(7)
    v_mfma_f32_16x16x32_bf16 v[32:35], v[64:67], v[184:187], 0
    v_mfma_f32_16x16x32_bf16 v[36:39], v[68:71], v[184:187], 0
    v_mfma_f32_16x16x32_bf16 v[32:35], v[72:75], v[188:191], v[32:35]
    v_mfma_f32_16x16x32_bf16 v[36:39], v[76:79], v[188:191], v[36:39]
    v_max3_f32 v132, v136, v137, v138
    v_max_f32 v132, v132, v139
    v_mul_f32 v4, 0xbfb8aa3b, v132
    v_fma_f32 v20, v136, s43, v4
    v_fma_f32 v21, v137, s43, v4
    v_fma_f32 v22, v138, s43, v4
    v_fma_f32 v23, v139, s43, v4
    v_exp_f32 v20, v20
    v_exp_f32 v21, v21
    v_exp_f32 v22, v22
    v_exp_f32 v23, v23
    s_waitcnt lgkmcnt(5)
    v_mfma_f32_16x16x32_bf16 v[40:43], v[80:83], v[192:195], 0
    v_mfma_f32_16x16x32_bf16 v[44:47], v[84:87], v[192:195], 0
    v_mfma_f32_16x16x32_bf16 v[40:43], v[88:91], v[196:199], v[40:43]
    v_mfma_f32_16x16x32_bf16 v[44:47], v[92:95], v[196:199], v[44:47]
    s_waitcnt lgkmcnt(3)
    v_mfma_f32_16x16x32_bf16 v[48:51], v[96:99], v[200:203], 0
    v_mfma_f32_16x16x32_bf16 v[52:55], v[100:103], v[200:203], 0
    v_cndmask_b32 v32, v32, v36, s[56:57]
    v_cndmask_b32 v33, v33, v37, s[56:57]
    v_cndmask_b32 v34, v34, v38, s[56:57]
    v_cndmask_b32 v35, v35, v39, s[56:57]
    v_mul_f32 v128, v32, v20
    v_mul_f32 v129, v33, v20
    v_mul_f32 v130, v34, v20
    v_mul_f32 v131, v35, v20
    v_mfma_f32_16x16x32_bf16 v[48:51], v[104:107], v[204:207], v[48:51]
    v_mfma_f32_16x16x32_bf16 v[52:55], v[108:111], v[204:207], v[52:55]
    s_waitcnt lgkmcnt(0)
    v_mfma_f32_16x16x32_bf16 v[56:59], v[112:115], v[208:211], 0
    v_mfma_f32_16x16x32_bf16 v[60:63], v[116:119], v[208:211], 0
    v_cndmask_b32 v40, v40, v44, s[56:57]
    v_cndmask_b32 v41, v41, v45, s[56:57]
    v_cndmask_b32 v42, v42, v46, s[56:57]
    v_cndmask_b32 v43, v43, v47, s[56:57]
    v_fmac_f32 v128, v40, v21
    v_fmac_f32 v129, v41, v21
    v_fmac_f32 v130, v42, v21
    v_fmac_f32 v131, v43, v21
    v_mfma_f32_16x16x32_bf16 v[56:59], v[120:123], v[212:215], v[56:59]
    v_mfma_f32_16x16x32_bf16 v[60:63], v[124:127], v[212:215], v[60:63]
    v_mul_f32 v133, v140, v20
    v_fmac_f32 v133, v141, v21
    v_fmac_f32 v133, v142, v22
    v_fmac_f32 v133, v143, v23
    s_nop 1
    v_add_f32_dpp v133, v133, v133 row_ror:4 row_mask:0xf bank_mask:0xf
    s_nop 1
    v_add_f32_dpp v133, v133, v133 row_ror:8 row_mask:0xf bank_mask:0xf
    v_mov_b32 v5, v133
    s_nop 1
    v_permlane16_swap_b32 v133, v5
    v_add_f32 v133, v133, v5
    v_mov_b32 v5, v133
    s_nop 1
    v_permlane32_swap_b32 v133, v5
    v_add_f32 v133, v133, v5
    v_subrev_u32 v133, 0x3f7ffc00, v133
    v_max_i32 v133, 0, v133
    v_lshrrev_b32 v133, 11, v133
    v_min_u32 v133, 0xffff, v133
    v_or_b32 v132, v132, v133
    v_mov_b32 v133, s46
    s_mov_b64 exec, 15
    s_cmp_eq_u32 s41, 0
    s_cbranch_scc0 Lst_27
    buffer_store_dwordx2 v[132:133], v147, s[36:39], s44 offen
Lst_28:
    s_mov_b64 exec, -1
    v_cndmask_b32 v48, v48, v52, s[56:57]
    v_cndmask_b32 v49, v49, v53, s[56:57]
    v_cndmask_b32 v50, v50, v54, s[56:57]
    v_cndmask_b32 v51, v51, v55, s[56:57]
    v_fmac_f32 v128, v48, v22
    v_fmac_f32 v129, v49, v22
    v_fmac_f32 v130, v50, v22
    v_fmac_f32 v131, v51, v22
    s_branch L_c_pvdone
L_c_pvslow:
    s_waitcnt lgkmcnt(0)
    v_max3_f32 v132, v136, v137, v138
    v_max_f32 v132, v132, v139
    v_mul_f32 v4, 0xbfb8aa3b, v132
    v_fma_f32 v20, v136, s43, v4
    v_fma_f32 v21, v137, s43, v4
    v_fma_f32 v22, v138, s43, v4
    v_fma_f32 v23, v139, s43, v4
    v_exp_f32 v20, v20
    v_exp_f32 v21, v21
    v_exp_f32 v22, v22
    v_exp_f32 v23, v23
    v_mul_f32 v133, v140, v20
    v_fmac_f32 v133, v141, v21
    v_fmac_f32 v133, v142, v22
    v_fmac_f32 v133, v143, v23
    s_nop 1
    v_add_f32_dpp v133, v133, v133 row_ror:4 row_mask:0xf bank_mask:0xf
    s_nop 1
    v_add_f32_dpp v133, v133, v133 row_ror:8 row_mask:0xf bank_mask:0xf
    v_mov_b32 v5, v133
    s_nop 1
    v_permlane16_swap_b32 v133, v5
    v_add_f32 v133, v133, v5
    v_mov_b32 v5, v133
    s_nop 1
    v_permlane32_swap_b32 v133, v5
    v_add_f32 v133, v133, v5
    v_subrev_u32 v133, 0x3f7ffc00, v133
    v_max_i32 v133, 0, v133
    v_lshrrev_b32 v133, 11, v133
    v_min_u32 v133, 0xffff, v133
    v_or_b32 v132, v132, v133
    v_mov_b32 v133, s46
    s_mov_b64 exec, 15
    s_cmp_eq_u32 s41, 0
    s_cbranch_scc0 Lst_29
    buffer_store_dwordx2 v[132:133], v147, s[36:39], s44 offen
Lst_30:
    s_mov_b64 exec, -1
    s_cmp_ge_i32 s40, 128
    s_cbranch_scc1 Lok_31
    s_mov_b32 s35, 0
Lsp_32:
    ds_read_b32 v9, v15 offset:0
    s_add_u32 s35, s35, 1
    s_cmp_lt_u32 s35, 2000000
    s_cbranch_scc0 L_end
    s_waitcnt lgkmcnt(0)
    v_readfirstlane_b32 s40, v9
    s_cmp_ge_i32 s40, 128
    s_cbranch_scc0 Lsp_32
Lok_31:
    ds_read_b64_tr_b16 v[64:65], v24 offset:0
    ds_read_b64_tr_b16 v[66:67], v24 offset:4096
    ds_read_b64_tr_b16 v[68:69], v25 offset:0
    ds_read_b64_tr_b16 v[70:71], v25 offset:4096
    ds_read_b64_tr_b16 v[72:73], v24 offset:8192
    ds_read_b64_tr_b16 v[74:75], v24 offset:12288
    ds_read_b64_tr_b16 v[76:77], v25 offset:8192
    ds_read_b64_tr_b16 v[78:79], v25 offset:12288
    ds_read_b64_tr_b16 v[80:81], v24 offset:16384
    ds_read_b64_tr_b16 v[82:83], v24 offset:20480
    ds_read_b64_tr_b16 v[84:85], v25 offset:16384
    ds_read_b64_tr_b16 v[86:87], v25 offset:20480
    ds_read_b64_tr_b16 v[88:89], v24 offset:24576
    ds_read_b64_tr_b16 v[90:91], v24 offset:28672
    ds_read_b64_tr_b16 v[92:93], v25 offset:24576
    ds_read_b64_tr_b16 v[94:95], v25 offset:28672
    s_waitcnt lgkmcnt(12)
    v_mfma_f32_16x16x32_bf16 v[32:35], v[64:67], v[184:187], 0
    v_mfma_f32_16x16x32_bf16 v[36:39], v[68:71], v[184:187], 0
    s_waitcnt lgkmcnt(8)
    v_mfma_f32_16x16x32_bf16 v[32:35], v[72:75], v[188:191], v[32:35]
    v_mfma_f32_16x16x32_bf16 v[36:39], v[76:79], v[188:191], v[36:39]
    s_waitcnt lgkmcnt(4)
    v_mfma_f32_16x16x32_bf16 v[40:43], v[80:83], v[192:195], 0
    v_mfma_f32_16x16x32_bf16 v[44:47], v[84:87], v[192:195], 0
    s_waitcnt lgkmcnt(0)
    v_mfma_f32_16x16x32_bf16 v[40:43], v[88:91], v[196:199], v[40:43]
    v_mfma_f32_16x16x32_bf16 v[44:47], v[92:95], v[196:199], v[44:47]
    s_cmp_ge_i32 s40, 144
    s_cbranch_scc1 Lok_33
    s_mov_b32 s35, 0
Lsp_34:
L_pad5:
    s_cbranch_execz L_pad6
    ds_read_b32 v9, v15 offset:0
    s_add_u32 s35, s35, 1
    s_cmp_lt_u32 s35, 2000000
    s_cbranch_scc0 L_end
    s_waitcnt lgkmcnt(0)
    v_readfirstlane_b32 s40, v9
    s_cmp_ge_i32 s40, 144
    s_cbranch_scc0 Lsp_34
Lok_33:
    ds_read_b64_tr_b16 v[64:65], v24 offset:32768
    ds_read_b64_tr_b16 v[66:67], v24 offset:36864
    ds_read_b64_tr_b16 v[68:69], v25 offset:32768
    ds_read_b64_tr_b16 v[70:71], v25 offset:36864
    ds_read_b64_tr_b16 v[72:73], v24 offset:40960
    ds_read_b64_tr_b16 v[74:75], v24 offset:45056
    ds_read_b64_tr_b16 v[76:77], v25 offset:40960
    ds_read_b64_tr_b16 v[78:79], v25 offset:45056
    v_cndmask_b32 v32, v32, v36, s[56:57]
    v_cndmask_b32 v33, v33, v37, s[56:57]
    v_cndmask_b32 v34, v34, v38, s[56:57]
    v_cndmask_b32 v35, v35, v39, s[56:57]
    v_mul_f32 v128, v32, v20
    v_mul_f32 v129, v33, v20
    v_mul_f32 v130, v34, v20
    v_mul_f32 v131, v35, v20
    v_cndmask_b32 v40, v40, v44, s[56:57]
    v_cndmask_b32 v41, v41, v45, s[56:57]
    v_cndmask_b32 v42, v42, v46, s[56:57]
    v_cndmask_b32 v43, v43, v47, s[56:57]
    v_fmac_f32 v128, v40, v21
    v_fmac_f32 v129, v41, v21
    v_fmac_f32 v130, v42, v21
    v_fmac_f32 v131, v43, v21
    s_waitcnt lgkmcnt(4)
    v_mfma_f32_16x16x32_bf16 v[48:51], v[64:67], v[200:203], 0
    v_mfma_f32_16x16x32_bf16 v[52:55], v[68:71], v[200:203], 0
    s_waitcnt lgkmcnt(0)
    v_mfma_f32_16x16x32_bf16 v[48:51], v[72:75], v[204:207], v[48:51]
    v_mfma_f32_16x16x32_bf16 v[52:55], v[76:79], v[204:207], v[52:55]
    s_cmp_ge_i32 s40, 152
    s_cbranch_scc1 Lok_35
    s_mov_b32 s35, 0
Lsp_36:
    ds_read_b32 v9, v15 offset:0
    s_add_u32 s35, s35, 1
    s_cmp_lt_u32 s35, 2000000
    s_cbranch_scc0 L_end
    s_waitcnt lgkmcnt(0)
    v_readfirstlane_b32 s40, v9
    s_cmp_ge_i32 s40, 152
    s_cbranch_scc0 Lsp_36
Lok_35:
    ds_read_b64_tr_b16 v[64:65], v24 offset:49152
    ds_read_b64_tr_b16 v[66:67], v24 offset:53248
    ds_read_b64_tr_b16 v[68:69], v25 offset:49152
    ds_read_b64_tr_b16 v[70:71], v25 offset:53248
    s_waitcnt lgkmcnt(0)
    v_mfma_f32_16x16x32_bf16 v[56:59], v[64:67], v[208:211], 0
    v_mfma_f32_16x16x32_bf16 v[60:63], v[68:71], v[208:211], 0
    s_cmp_ge_i32 s40, 160
    s_cbranch_scc1 Lok_37
    s_mov_b32 s35, 0
Lsp_38:
    ds_read_b32 v9, v15 offset:0
    s_add_u32 s35, s35, 1
    s_cmp_lt_u32 s35, 2000000
    s_cbranch_scc0 L_end
    s_waitcnt lgkmcnt(0)
    v_readfirstlane_b32 s40, v9
    s_cmp_ge_i32 s40, 160
    s_cbranch_scc0 Lsp_38
Lok_37:
    ds_read_b64_tr_b16 v[64:65], v24 offset:57344
    ds_read_b64_tr_b16 v[66:67], v24 offset:61440
    ds_read_b64_tr_b16 v[68:69], v25 offset:57344
    ds_read_b64_tr_b16 v[70:71], v25 offset:61440
    v_cndmask_b32 v48, v48, v52, s[56:57]
    v_cndmask_b32 v49, v49, v53, s[56:57]
    v_cndmask_b32 v50, v50, v54, s[56:57]
    v_cndmask_b32 v51, v51, v55, s[56:57]
    v_fmac_f32 v128, v48, v22
    v_fmac_f32 v129, v49, v22
    v_fmac_f32 v130, v50, v22
    v_fmac_f32 v131, v51, v22
    s_waitcnt lgkmcnt(0)
    v_mfma_f32_16x16x32_bf16 v[56:59], v[64:67], v[212:215], v[56:59]
    v_mfma_f32_16x16x32_bf16 v[60:63], v[68:71], v[212:215], v[60:63]
L_c_pvdone:
    s_mov_b32 exec_lo, 0x00ff00ff
    s_mov_b32 exec_hi, 0x00ff00ff
    s_nop 5
    v_cndmask_b32 v56, v56, v60, s[56:57]
    v_cndmask_b32 v57, v57, v61, s[56:57]
    v_cndmask_b32 v58, v58, v62, s[56:57]
    v_cndmask_b32 v59, v59, v63, s[56:57]
    v_fmac_f32 v128, v56, v23
    v_fmac_f32 v129, v57, v23
    v_fmac_f32 v130, v58, v23
    v_fmac_f32 v131, v59, v23
    v_and_or_b32 v128, v128, s34, v17
    v_and_or_b32 v130, v130, s34, v17
    s_cmp_eq_u32 s41, 0
    s_cbranch_scc0 Lst_39
    buffer_store_dwordx4 v[128:131], v154, s[36:39], s96 offen
Lst_40:
    s_mov_b64 exec, 1
    ds_add_u32 v15, v16 offset:36
    s_mov_b64 exec, -1
    s_mov_b32 s62, 0x000c000c
    s_mov_b32 s63, 0x000c000c
    s_cmp_eq_u32 s55, 1
    s_cbranch_scc1 L_ffn
    s_cmp_eq_u32 s55, 0
    s_cbranch_scc1 L_wo
    s_endpgm
L_wo:
    s_mov_b32 s44, 0x3fb8aa3b
    s_lshl_b32 s45, s32, 7
    s_add_u32 s45, s45, 278528
    s_lshl_b32 s42, s33, 2
    s_add_u32 s42, s42, s3
    s_cmp_eq_u32 s42, 0
    s_cselect_b32 s45, s45, 0x400000
    v_and_b32 v7, 31, v0
    v_lshlrev_b32 v7, 2, v7
    buffer_load_dwordx4 v[24:27], v156, s[36:39], s100 offen sc1
    buffer_load_dwordx4 v[28:31], v156, s[36:39], s100 offen offset:16 sc1
    s_mov_b32 s48, 0
    s_cmp_ge_i32 s40, 192
    s_cbranch_scc1 Lok_41
    s_mov_b32 s35, 0
Lsp_42:
    ds_read_b32 v9, v15 offset:0
    s_add_u32 s35, s35, 1
    s_cmp_lt_u32 s35, 2000000
    s_cbranch_scc0 L_end
    s_waitcnt lgkmcnt(0)
    v_readfirstlane_b32 s40, v9
    s_cmp_ge_i32 s40, 192
    s_cbranch_scc0 Lsp_42
Lok_41:
    buffer_load_dwordx4 v[136:139], v156, s[36:39], s100 offen sc1
    buffer_load_dwordx4 v[140:143], v156, s[36:39], s100 offen offset:16 sc1
    buffer_load_dwordx4 v[32:35], v152, s[36:39], s99 offen offset:0 sc1
    buffer_load_dwordx4 v[36:39], v152, s[36:39], s99 offen offset:1024 sc1
    buffer_load_dwordx4 v[40:43], v152, s[36:39], s99 offen offset:2048 sc1
    buffer_load_dwordx4 v[44:47], v152, s[36:39], s99 offen offset:3072 sc1
    ds_read_b64_tr_b16 v[64:65], v13 offset:16384
    ds_read_b64_tr_b16 v[66:67], v13 offset:20480
    ds_read_b64_tr_b16 v[68:69], v14 offset:16384
    ds_read_b64_tr_b16 v[70:71], v14 offset:20480
    ds_read_b64_tr_b16 v[72:73], v13 offset:24576
    ds_read_b64_tr_b16 v[74:75], v13 offset:28672
    ds_read_b64_tr_b16 v[76:77], v14 offset:24576
    ds_read_b64_tr_b16 v[78:79], v14 offset:28672
    ds_read_b64_tr_b16 v[80:81], v13 offset:32768
    ds_read_b64_tr_b16 v[82:83], v13 offset:36864
    ds_read_b64_tr_b16 v[84:85], v14 offset:32768
    ds_read_b64_tr_b16 v[86:87], v14 offset:36864
    ds_read_b64_tr_b16 v[88:89], v13 offset:40960
    ds_read_b64_tr_b16 v[90:91], v13 offset:45056
    ds_read_b64_tr_b16 v[92:93], v14 offset:40960
    ds_read_b64_tr_b16 v[94:95], v14 offset:45056
    s_mov_b32 s35, 0
    s_waitcnt vmcnt(6)
L_wo_st:
    v_xor_b32 v6, s46, v25
    v_bitop3_b32 v6, v27, s46, v6 bitop3:0xbe
    v_bitop3_b32 v6, v29, s46, v6 bitop3:0xbe
    v_bitop3_b32 v6, v31, s46, v6 bitop3:0xbe
    v_cmp_ne_u32 vcc, 0, v6
    v_and_b32 v25, 0xffff, v24
    v_and_b32 v24, 0xffff0000, v24
L_pad6:
    s_cbranch_execz L_pad7
    v_and_b32 v27, 0xffff, v26
    v_and_b32 v26, 0xffff0000, v26
    v_and_b32 v29, 0xffff, v28
    v_and_b32 v28, 0xffff0000, v28
    v_and_b32 v31, 0xffff, v30
    v_and_b32 v30, 0xffff0000, v30
    v_max3_f32 v4, v24, v26, v28
    v_max_f32 v4, v4, v30
    s_cbranch_vccnz L_wo_st2
    v_mov_b32 v5, v4
    s_nop 1
    v_permlane16_swap_b32 v4, v5
    v_max_f32 v4, v4, v5
    v_mov_b32 v5, v4
    s_nop 1
    v_permlane32_swap_b32 v4, v5
    v_max_f32 v4, v4, v5
    v_mul_f32 v4, 0xbfb8aa3b, v4
    v_fma_f32 v20, v24, s44, v4
    v_fma_f32 v21, v26, s44, v4
    v_fma_f32 v22, v28, s44, v4
    v_fma_f32 v23, v30, s44, v4
    v_exp_f32 v20, v20
    v_exp_f32 v21, v21
    v_exp_f32 v22, v22
    v_exp_f32 v23, v23
    v_lshl_add_u32 v25, v25, 11, 1.0
    v_lshl_add_u32 v27, v27, 11, 1.0
    v_lshl_add_u32 v29, v29, 11, 1.0
    v_lshl_add_u32 v31, v31, 11, 1.0
    v_mul_f32 v5, v20, v25
    v_fmac_f32 v5, v21, v27
    v_fmac_f32 v5, v22, v29
    v_fmac_f32 v5, v23, v31
    v_mov_b32 v4, v5
    s_nop 1
    v_permlane16_swap_b32 v5, v4
    v_add_f32 v5, v5, v4
    v_mov_b32 v4, v5
    s_nop 1
    v_permlane32_swap_b32 v5, v4
    v_add_f32 v5, v5, v4
    v_rcp_f32 v5, v5
    s_mov_b32 s35, 0
    s_branch Lchk_44
Ltry_43:
    buffer_load_dwordx4 v[32:35], v152, s[36:39], s99 offen offset:0 sc1
    buffer_load_dwordx4 v[36:39], v152, s[36:39], s99 offen offset:1024 sc1
    buffer_load_dwordx4 v[40:43], v152, s[36:39], s99 offen offset:2048 sc1
    buffer_load_dwordx4 v[44:47], v152, s[36:39], s99 offen offset:3072 sc1
    s_add_u32 s35, s35, 1
    s_cmp_lt_u32 s35, 200000
    s_cbranch_scc0 L_end
Lchk_44:
    s_waitcnt vmcnt(3)
    v_xor_b32 v32, s31, v32
    v_xor_b32 v34, s31, v34
    v_or_b32 v9, v32, v34
    v_mul_f32 v32, v32, v20
    v_mul_f32 v33, v33, v20
    v_mul_f32 v34, v34, v20
    v_mul_f32 v35, v35, v20
    s_waitcnt vmcnt(2)
    v_xor_b32 v36, s31, v36
    v_xor_b32 v38, s31, v38
    v_or3_b32 v9, v36, v38, v9
    v_fmac_f32 v32, v36, v21
    v_fmac_f32 v33, v37, v21
    v_fmac_f32 v34, v38, v21
    v_fmac_f32 v35, v39, v21
    s_waitcnt vmcnt(1)
    v_xor_b32 v40, s31, v40
    v_xor_b32 v42, s31, v42
    v_or3_b32 v9, v40, v42, v9
    v_fmac_f32 v32, v40, v22
    v_fmac_f32 v33, v41, v22
    v_fmac_f32 v34, v42, v22
    v_fmac_f32 v35, v43, v22
    s_waitcnt vmcnt(0)
    v_xor_b32 v44, s31, v44
    v_xor_b32 v46, s31, v46
    v_or3_b32 v9, v44, v46, v9
    v_and_b32 v8, 0xff, v9
    v_cmp_ne_u32 vcc, 0, v8
    v_fmac_f32 v32, v44, v23
    v_fmac_f32 v33, v45, v23
    v_fmac_f32 v34, v46, v23
    v_fmac_f32 v35, v47, v23
    s_cbranch_vccnz Ltry_43
    buffer_store_dword v17, v7, s[36:39], s45 offen sc1
    v_permlane32_swap_b32 v32, v34
    v_permlane32_swap_b32 v33, v35
    v_add_f32 v32, v32, v34
    v_add_f32 v33, v33, v35
    s_nop 1
    v_permlane16_swap_b32 v32, v33
    v_add_f32 v4, v32, v33
    v_mul_f32 v4, v4, v5
    v_cvt_pk_bf16_f32 v4, v4, v4
    ds_write_b16 v11, v4 offset:7296
    s_waitcnt lgkmcnt(0)
    s_barrier
    ds_read_b128 v[48:51], v10 offset:7296
    ds_read_b128 v[52:55], v10 offset:7360
    ds_read_b128 v[56:59], v10 offset:7424
    ds_read_b128 v[60:63], v10 offset:7488
    s_waitcnt lgkmcnt(3)
    v_mfma_f32_16x16x32_bf16 v[128:131], v[64:67], v[48:51], 0
    v_mfma_f32_16x16x32_bf16 v[132:135], v[68:71], v[48:51], 0
    s_waitcnt lgkmcnt(2)
    v_mfma_f32_16x16x32_bf16 v[128:131], v[72:75], v[52:55], v[128:131]
    v_mfma_f32_16x16x32_bf16 v[132:135], v[76:79], v[52:55], v[132:135]
    s_waitcnt lgkmcnt(1)
    v_mfma_f32_16x16x32_bf16 v[128:131], v[80:83], v[56:59], v[128:131]
    v_mfma_f32_16x16x32_bf16 v[132:135], v[84:87], v[56:59], v[132:135]
    s_waitcnt lgkmcnt(0)
    v_mfma_f32_16x16x32_bf16 v[128:131], v[88:91], v[60:63], v[128:131]
    v_mfma_f32_16x16x32_bf16 v[132:135], v[92:95], v[60:63], v[132:135]
    s_mov_b32 exec_lo, 0x000f000f
    s_mov_b32 exec_hi, 0x000f000f
    s_nop 5
    v_cndmask_b32 v128, v128, v132, s[62:63]
    v_cndmask_b32 v129, v129, v133, s[62:63]
    v_cndmask_b32 v130, v130, v134, s[62:63]
    v_cndmask_b32 v131, v131, v135, s[62:63]
    v_and_or_b32 v128, v128, s34, v17
    v_and_or_b32 v130, v130, s34, v17
    buffer_store_dwordx4 v[128:131], v155, s[36:39], s97 offen sc1
    s_mov_b64 exec, -1
    s_cmp_lt_u32 s32, 4
    s_cbranch_scc1 L_wo_b
    s_sub_u32 s53, s53, s32
    s_add_u32 s53, s53, 4
    s_cmp_lt_u32 s33, 12
    s_cbranch_scc1 L_wo_b
    s_endpgm
L_wo_b:
    v_and_b32 v4, 15, v0
    v_lshlrev_b32 v5, 1, v1
    v_xor_b32 v4, v4, v5
    v_lshlrev_b32 v4, 4, v4
    v_lshl_add_u32 v24, v1, 10, v4
    v_xor_b32 v25, 0x80, v24
    s_mov_b32 s4, s18
    s_mov_b32 s5, s19
    s_mov_b32 s6, 1835008
    s_mov_b32 s7, 0x20000
    s_lshl_b32 s42, s53, 16
    s_lshl_b32 s43, s54, 8
    s_add_u32 s42, s42, s43
    s_lshl_b32 s43, s3, 14
    s_add_u32 s46, s42, s43
    s_lshl_b32 s43, s3, 12
    s_add_u32 s47, s43, 49152
    s_mov_b32 m0, s47
    s_add_u32 s47, s47, 1024
    buffer_load_dwordx4 v24, s[4:7], s46 offen nt lds
    s_add_u32 s46, s46, 4096
    s_mov_b32 m0, s47
    s_add_u32 s47, s47, 1024
    buffer_load_dwordx4 v25, s[4:7], s46 offen nt lds
    s_add_u32 s46, s46, 4096
    s_mov_b32 m0, s47
    s_add_u32 s47, s47, 1024
    buffer_load_dwordx4 v24, s[4:7], s46 offen nt lds
    s_add_u32 s46, s46, 4096
    s_mov_b32 m0, s47
    s_add_u32 s47, s47, 1024
    buffer_load_dwordx4 v25, s[4:7], s46 offen nt lds
    s_add_u32 s46, s46, 4096
    v_and_b32 v4, 1, v0
    v_bfe_u32 v5, v0, 1, 1
    v_lshl_add_u32 v5, v5, 6, v150
    v_mul_u32_u24 v4, 3584, v4
    v_add_u32 v156, v4, v5
    s_lshl_b32 s42, s54, 2
    s_add_u32 s42, s42, s3
    s_mul_i32 s42, s42, 7168
    s_lshl_b32 s43, s53, 7
    s_add_u32 s42, s42, s43
    s_add_u32 s98, s42, 655360
    s_lshl_b32 s42, s53, 2
    s_add_u32 s42, s42, s3
    s_lshl_b32 s42, s42, 11
    s_add_u32 s100, s42, 425984
    v_bfe_u32 v4, v0, 2, 1
    v_mul_u32_u24 v4, 320, v4
    v_and_b32 v5, 3, v0
    v_lshl_add_u32 v4, v5, 4, v4
L_pad7:
    s_cbranch_execz L_pad8
    v_lshl_add_u32 v4, v1, 1, v4
    s_lshr_b32 s42, s3, 1
    s_lshl_b32 s42, s42, 6
    s_and_b32 s43, s3, 1
    s_lshl_b32 s43, s43, 3
    s_add_u32 s42, s42, s43
    s_add_u32 s42, s42, 155392
    v_add_u32 v158, s42, v4
    s_lshl_b32 s42, s53, 2
    s_add_u32 s42, s42, s54
    s_lshl_b32 s42, s42, 8
    s_add_u32 s49, s42, 851968
    s_lshr_b32 s42, s53, 1
    s_cmp_eq_u32 s42, s3
    s_cselect_b32 s49, s49, 0x400000
    v_lshlrev_b32 v159, 2, v0
    s_add_u32 s50, s30, 1
    s_and_b32 s50, s50, 0xffff
    v_xor_b32 v32, 0x55, v17
    v_mov_b32 v34, v32
    s_mov_b32 exec_lo, 0x000f000f
    s_mov_b32 exec_hi, 0x000f000f
    buffer_store_dwordx4 v[32:35], v156, s[36:39], s98 offen sc1
    s_mov_b64 exec, -1
    buffer_load_dword v23, v159, s[36:39], s49 offen sc1
    buffer_load_dwordx4 v[112:115], v152, s[36:39], s100 offen sc1
    buffer_load_dwordx4 v[116:119], v152, s[36:39], s100 offen offset:1024 sc1
    v_and_b32 v4, 3, v0
    v_lshlrev_b32 v4, 4, v4
    v_bfe_u32 v5, v0, 2, 1
    v_lshl_add_u32 v7, v2, 6, v4
    v_lshl_add_u32 v7, v5, 7, v7
    v_lshl_add_u32 v7, v1, 9, v7
    s_lshl_b32 s42, s54, 1
    s_lshr_b32 s43, s3, 1
    s_add_u32 s42, s42, s43
    s_lshl_b32 s48, s42, 11
    s_and_b32 s43, s3, 1
    s_lshl_b32 s43, s43, 8
    s_add_u32 s48, s48, s43
    s_lshr_b32 s43, s42, 1
    s_add_u32 s43, s43, 4
    s_cmp_eq_u32 s43, s32
    s_cselect_b32 s43, 0, 1
    s_lshl_b32 s43, s43, 21
    s_add_u32 s43, s43, s48
    s_add_u32 s44, s43, 90112
    s_mov_b32 s35, 0
Ltry_45:
    buffer_load_dwordx4 v[96:99], v7, s[36:39], s44 offen offset:0 sc1
    s_add_u32 s35, s35, 1
    s_cmp_lt_u32 s35, 24
    s_cselect_b32 s43, 0, 0x200000
    s_or_b32 s44, s44, s43
    s_cmp_lt_u32 s35, 200000
    s_cbranch_scc0 L_end
Lchk_46:
    s_waitcnt vmcnt(0)
    v_xor_b32 v96, s31, v96
    v_xor_b32 v98, s31, v98
    v_or_b32 v9, v96, v98
    v_and_b32 v8, 0xff, v9
    v_cmp_ne_u32 vcc, 0, v8
    s_cbranch_vccnz Ltry_45
    v_permlane32_swap_b32 v96, v98
    v_permlane32_swap_b32 v97, v99
    v_add_f32 v96, v96, v98
    v_add_f32 v97, v97, v99
    s_nop 1
    v_permlane16_swap_b32 v96, v97
    v_add_f32 v21, v96, v97
    v_cvt_pk_bf16_f32 v8, v21, v21
    v_lshlrev_b32 v21, 16, v8
    s_barrier
    ds_read_b64_tr_b16 v[64:65], v13 offset:49152
    ds_read_b64_tr_b16 v[66:67], v13 offset:53248
    ds_read_b64_tr_b16 v[68:69], v14 offset:49152
    ds_read_b64_tr_b16 v[70:71], v14 offset:53248
    ds_read_b64_tr_b16 v[72:73], v13 offset:57344
    ds_read_b64_tr_b16 v[74:75], v13 offset:61440
    ds_read_b64_tr_b16 v[76:77], v14 offset:57344
    ds_read_b64_tr_b16 v[78:79], v14 offset:61440
    s_branch L_ffnb
L_wo_st2:
    s_cmp_eq_u32 s48, 0
    s_cbranch_scc0 L_wo_st3
    s_mov_b32 s48, 1
    s_waitcnt vmcnt(4)
    v_mov_b32 v24, v136
    v_mov_b32 v25, v137
    v_mov_b32 v26, v138
    v_mov_b32 v27, v139
    v_mov_b32 v28, v140
    v_mov_b32 v29, v141
    v_mov_b32 v30, v142
    v_mov_b32 v31, v143
    s_branch L_wo_st
L_wo_st3:
    buffer_load_dwordx4 v[24:27], v156, s[36:39], s100 offen sc1
    buffer_load_dwordx4 v[28:31], v156, s[36:39], s100 offen offset:16 sc1
    buffer_load_dwordx4 v[32:35], v152, s[36:39], s99 offen offset:0 sc1
    buffer_load_dwordx4 v[36:39], v152, s[36:39], s99 offen offset:1024 sc1
    buffer_load_dwordx4 v[40:43], v152, s[36:39], s99 offen offset:2048 sc1
    buffer_load_dwordx4 v[44:47], v152, s[36:39], s99 offen offset:3072 sc1
    s_add_u32 s35, s35, 1
    s_cmp_lt_u32 s35, 200000
    s_cbranch_scc0 L_end
    s_waitcnt vmcnt(4)
    s_branch L_wo_st
L_ffn:
    s_lshl_b32 s42, s54, 1
    s_lshr_b32 s43, s3, 1
    s_add_u32 s42, s42, s43
    s_lshl_b32 s48, s42, 11
    s_and_b32 s43, s3, 1
    s_lshl_b32 s43, s43, 8
    s_add_u32 s48, s48, s43
    s_lshr_b32 s43, s42, 2
    s_add_u32 s43, s43, 4
    s_cmp_eq_u32 s43, s32
    s_cselect_b32 s43, 0, 1
    s_lshl_b32 s43, s43, 21
    s_add_u32 s43, s43, s48
    s_add_u32 s44, s43, 40960
    s_lshr_b32 s43, s42, 2
    s_add_u32 s43, s43, 6
    s_cmp_eq_u32 s43, s32
    s_cselect_b32 s43, 0, 1
    s_lshl_b32 s43, s43, 21
    s_add_u32 s43, s43, s48
    s_add_u32 s45, s43, 57344
    s_lshr_b32 s43, s42, 1
    s_add_u32 s43, s43, 0
    s_cmp_eq_u32 s43, s32
    s_cselect_b32 s43, 0, 1
    s_lshl_b32 s43, s43, 21
    s_add_u32 s43, s43, s48
    s_add_u32 s46, s43, 73728
    s_mov_b32 s35, 0
Ltry_47:
    buffer_load_dwordx4 v[96:99], v7, s[36:39], s44 offen offset:0 sc1
    buffer_load_dwordx4 v[100:103], v7, s[36:39], s45 offen offset:0 sc1
    buffer_load_dwordx4 v[104:107], v7, s[36:39], s46 offen offset:0 sc1
    s_add_u32 s35, s35, 1
    s_cmp_lt_u32 s35, 24
    s_cselect_b32 s43, 0, 0x200000
    s_or_b32 s44, s44, s43
    s_or_b32 s45, s45, s43
    s_or_b32 s46, s46, s43
    s_cmp_lt_u32 s35, 200000
    s_cbranch_scc0 L_end
Lchk_48:
    s_waitcnt vmcnt(2)
    v_xor_b32 v96, s31, v96
    v_xor_b32 v98, s31, v98
    v_or_b32 v9, v96, v98
    s_waitcnt vmcnt(1)
    v_xor_b32 v100, s31, v100
    v_xor_b32 v102, s31, v102
    v_or3_b32 v9, v100, v102, v9
    s_waitcnt vmcnt(0)
    v_xor_b32 v104, s31, v104
    v_xor_b32 v106, s31, v106
    v_or3_b32 v9, v104, v106, v9
    v_and_b32 v8, 0xff, v9
    v_cmp_ne_u32 vcc, 0, v8
    s_cbranch_vccnz Ltry_47
    v_permlane32_swap_b32 v96, v98
    v_permlane32_swap_b32 v97, v99
    v_permlane32_swap_b32 v100, v102
    v_permlane32_swap_b32 v101, v103
    v_permlane32_swap_b32 v104, v106
    v_permlane32_swap_b32 v105, v107
    v_add_f32 v96, v96, v98
    v_add_f32 v97, v97, v99
    v_add_f32 v100, v100, v102
    v_add_f32 v101, v101, v103
    v_add_f32 v104, v104, v106
    v_add_f32 v105, v105, v107
    v_permlane16_swap_b32 v96, v97
    v_permlane16_swap_b32 v100, v101
    v_permlane16_swap_b32 v104, v105
    v_add_f32 v20, v96, v97
    v_add_f32 v4, v100, v101
    v_add_f32 v22, v104, v105
    v_cvt_pk_bf16_f32 v8, v20, v20
    v_lshlrev_b32 v20, 16, v8
    v_cvt_pk_bf16_f32 v8, v4, v4
    v_lshlrev_b32 v4, 16, v8
    v_cvt_pk_bf16_f32 v8, v22, v22
    v_lshlrev_b32 v22, 16, v8
    v_add_f32 v22, 1.0, v22
    v_cvt_pk_bf16_f32 v8, v22, v22
    v_lshlrev_b32 v22, 16, v8
    ds_write_b16_d16_hi v149, v22 offset:9120
    ds_write_b16_d16_hi v149, v4 offset:10752
    v_mov_b32 v5, 0x3f80
    ds_write_b16 v149, v5 offset:10208
    s_add_u32 s44, s99, 4096
    s_mov_b32 s60, 0x00300030
    s_mov_b32 s61, 0x00300030
    v_and_b32 v7, 7, v0
    v_lshlrev_b32 v7, 7, v7
    s_mov_b32 s45, 278528
L_pad8:
    s_cbranch_execz L_pad9
    s_cmp_ge_i32 s40, 192
    s_cbranch_scc1 Lok_49
    s_mov_b32 s35, 0
Lsp_50:
    ds_read_b32 v9, v15 offset:0
    s_add_u32 s35, s35, 1
    s_cmp_lt_u32 s35, 2000000
    s_cbranch_scc0 L_end
    s_waitcnt lgkmcnt(0)
    v_readfirstlane_b32 s40, v9
    s_cmp_ge_i32 s40, 192
    s_cbranch_scc0 Lsp_50
Lok_49:
    ds_read_b64_tr_b16 v[32:33], v12 offset:16384
    ds_read_b64_tr_b16 v[34:35], v12 offset:18432
    ds_read_b64_tr_b16 v[36:37], v12 offset:20480
    ds_read_b64_tr_b16 v[38:39], v12 offset:22528
    ds_read_b64_tr_b16 v[40:41], v12 offset:24576
    ds_read_b64_tr_b16 v[42:43], v12 offset:26624
    ds_read_b64_tr_b16 v[44:45], v12 offset:28672
    ds_read_b64_tr_b16 v[46:47], v12 offset:30720
    s_lshl_b32 s42, s53, 2
    s_add_u32 s42, s42, s54
    s_lshl_b32 s42, s42, 8
    s_add_u32 s49, s42, 851968
    s_lshr_b32 s42, s53, 1
    s_cmp_eq_u32 s42, s3
    s_cselect_b32 s49, s49, 0x400000
    v_lshlrev_b32 v159, 2, v0
    s_add_u32 s50, s30, 1
    s_and_b32 s50, s50, 0xffff
    s_mov_b32 s35, 0
L_hint:
    buffer_load_dword v6, v7, s[36:39], s45 offen sc1
    s_add_u32 s35, s35, 1
    s_cmp_lt_u32 s35, 200000
    s_cbranch_scc0 L_hinted
    s_waitcnt vmcnt(0)
    v_cmp_ne_u32 vcc, s31, v6
    s_cbranch_vccnz L_hint
L_hinted:
    s_mov_b32 s35, 0
Ltry_51:
    buffer_load_dwordx4 v[96:99], v152, s[36:39], s99 offen offset:0 sc1
    buffer_load_dwordx4 v[100:103], v152, s[36:39], s99 offen offset:1024 sc1
    buffer_load_dwordx4 v[104:107], v152, s[36:39], s99 offen offset:2048 sc1
    buffer_load_dwordx4 v[108:111], v152, s[36:39], s99 offen offset:3072 sc1
    buffer_load_dwordx4 v[112:115], v152, s[36:39], s44 offen offset:0 sc1
    buffer_load_dwordx4 v[116:119], v152, s[36:39], s44 offen offset:1024 sc1
    buffer_load_dwordx4 v[120:123], v152, s[36:39], s44 offen offset:2048 sc1
    buffer_load_dwordx4 v[124:127], v152, s[36:39], s44 offen offset:3072 sc1
    s_add_u32 s35, s35, 1
    s_cmp_lt_u32 s35, 200000
    s_cbranch_scc0 L_end
Lchk_52:
    s_waitcnt vmcnt(7)
    v_xor_b32 v96, s31, v96
    v_xor_b32 v98, s31, v98
    v_or_b32 v9, v96, v98
    s_waitcnt vmcnt(6)
    v_xor_b32 v100, s31, v100
    v_xor_b32 v102, s31, v102
    v_or3_b32 v9, v100, v102, v9
    v_pk_add_f32 v[96:97], v[96:97], v[100:101]
    v_pk_add_f32 v[98:99], v[98:99], v[102:103]
    s_waitcnt vmcnt(5)
    v_xor_b32 v104, s31, v104
    v_xor_b32 v106, s31, v106
    v_or3_b32 v9, v104, v106, v9
    v_pk_add_f32 v[96:97], v[96:97], v[104:105]
    v_pk_add_f32 v[98:99], v[98:99], v[106:107]
    s_waitcnt vmcnt(4)
    v_xor_b32 v108, s31, v108
    v_xor_b32 v110, s31, v110
    v_or3_b32 v9, v108, v110, v9
    v_pk_add_f32 v[96:97], v[96:97], v[108:109]
    v_pk_add_f32 v[98:99], v[98:99], v[110:111]
    s_waitcnt vmcnt(3)
    v_xor_b32 v112, s31, v112
    v_xor_b32 v114, s31, v114
    v_or3_b32 v9, v112, v114, v9
    v_pk_add_f32 v[96:97], v[96:97], v[112:113]
    v_pk_add_f32 v[98:99], v[98:99], v[114:115]
    s_waitcnt vmcnt(2)
    v_xor_b32 v116, s31, v116
    v_xor_b32 v118, s31, v118
    v_or3_b32 v9, v116, v118, v9
    v_pk_add_f32 v[96:97], v[96:97], v[116:117]
    v_pk_add_f32 v[98:99], v[98:99], v[118:119]
    s_waitcnt vmcnt(1)
    v_xor_b32 v120, s31, v120
    v_xor_b32 v122, s31, v122
    v_or3_b32 v9, v120, v122, v9
    v_pk_add_f32 v[96:97], v[96:97], v[120:121]
    v_pk_add_f32 v[98:99], v[98:99], v[122:123]
    s_waitcnt vmcnt(0)
    v_xor_b32 v124, s31, v124
    v_xor_b32 v126, s31, v126
    v_or3_b32 v9, v124, v126, v9
    v_and_b32 v8, 0xff, v9
    v_cmp_ne_u32 vcc, 0, v8
    v_pk_add_f32 v[96:97], v[96:97], v[124:125]
    v_pk_add_f32 v[98:99], v[98:99], v[126:127]
    s_cbranch_vccnz Ltry_51
    s_nop 0
    v_permlane32_swap_b32 v96, v98
    v_permlane32_swap_b32 v97, v99
    v_add_f32 v96, v96, v98
    v_add_f32 v97, v97, v99
    s_nop 1
    v_permlane16_swap_b32 v96, v97
    v_add_f32 v4, v96, v97
    v_fma_f32 v23, v20, v4, v19
    v_cvt_pk_bf16_f32 v5, v23, v23
    v_lshlrev_b32 v23, 16, v5
    ds_write_b16 v149, v5 offset:9664
    v_mul_f32 v4, v23, v22
    v_cvt_pk_bf16_f32 v4, v4, v4
    ds_write_b16 v149, v4 offset:8576
    s_waitcnt lgkmcnt(0)
    s_barrier
    ds_read_b128 v[48:51], v157 offset:8576
    ds_read_b128 v[52:55], v157 offset:8640
    ds_read_b128 v[56:59], v157 offset:8704
    ds_read_b128 v[60:63], v157 offset:8768
    s_waitcnt lgkmcnt(3)
    v_mfma_f32_16x16x32_bf16 v[128:131], v[32:35], v[48:51], 0
    v_mfma_f32_16x16x32_bf16 v[132:135], v[48:51], v[48:51], 0
    s_waitcnt lgkmcnt(2)
    v_mfma_f32_16x16x32_bf16 v[128:131], v[36:39], v[52:55], v[128:131]
    v_mfma_f32_16x16x32_bf16 v[132:135], v[52:55], v[52:55], v[132:135]
    s_waitcnt lgkmcnt(1)
    v_mfma_f32_16x16x32_bf16 v[128:131], v[40:43], v[56:59], v[128:131]
    v_mfma_f32_16x16x32_bf16 v[132:135], v[56:59], v[56:59], v[132:135]
    s_waitcnt lgkmcnt(0)
    v_mfma_f32_16x16x32_bf16 v[128:131], v[44:47], v[60:63], v[128:131]
    v_mfma_f32_16x16x32_bf16 v[132:135], v[60:63], v[60:63], v[132:135]
    s_mov_b32 exec_lo, 0x033f033f
    s_mov_b32 exec_hi, 0x033f033f
    s_nop 5
    v_cndmask_b32 v128, v128, v132, s[60:61]
    v_cndmask_b32 v129, v129, v133, s[60:61]
    v_cndmask_b32 v130, v130, v134, s[60:61]
    v_cndmask_b32 v131, v131, v135, s[60:61]
    v_and_or_b32 v128, v128, s34, v17
    v_and_or_b32 v130, v130, s34, v17
    s_cmp_eq_u32 s41, 0
    s_cbranch_scc0 Lst_53
    buffer_store_dwordx4 v[128:131], v155, s[36:39], s97 offen
Lst_54:
    s_mov_b64 exec, -1
    v_or_b32 v23, s50, v23
    s_cmp_eq_u32 s41, 0
    s_cbranch_scc0 Lst_55
    buffer_store_dword v23, v159, s[36:39], s49 offen
Lst_56:
    s_endpgm
L_ffnb:
    s_mov_b32 s35, 0
Ltry_57:
    buffer_load_dwordx4 v[96:99], v152, s[36:39], s100 offen offset:0 sc1
    buffer_load_dwordx4 v[100:103], v152, s[36:39], s100 offen offset:1024 sc1
    s_add_u32 s35, s35, 1
    s_cmp_lt_u32 s35, 200000
    s_cbranch_scc0 L_end
Lchk_58:
    s_waitcnt vmcnt(1)
    v_xor_b32 v96, s31, v96
    v_xor_b32 v98, s31, v98
    v_or_b32 v9, v96, v98
    s_waitcnt vmcnt(0)
    v_xor_b32 v100, s31, v100
    v_xor_b32 v102, s31, v102
    v_or3_b32 v9, v100, v102, v9
    v_and_b32 v8, 0xff, v9
    v_cmp_ne_u32 vcc, 0, v8
    s_cbranch_vccnz Ltry_57
    v_permlane32_swap_b32 v100, v102
    v_permlane32_swap_b32 v101, v103
    v_permlane32_swap_b32 v96, v98
    v_permlane32_swap_b32 v97, v99
    v_add_f32 v100, v100, v102
    v_add_f32 v101, v101, v103
    v_add_f32 v96, v96, v98
    v_add_f32 v97, v97, v99
    v_permlane16_swap_b32 v100, v101
    s_nop 0
    v_permlane16_swap_b32 v96, v97
    v_add_f32 v5, v100, v101
    v_add_f32 v4, v96, v97
L_pad9:
    s_cbranch_execz L_pad10
    v_readlane_b32 s42, v5, 1
    v_readlane_b32 s43, v5, 21
    v_readlane_b32 s44, v5, 33
    v_readlane_b32 s45, v5, 37
    v_mov_b32_dpp v6, v4 row_ror:8 row_mask:0xf bank_mask:0xf
    v_mov_b32_dpp v7, v5 row_ror:8 row_mask:0xf bank_mask:0xf
    v_mov_b32 v8, s42
    v_mov_b32 v9, s44
    s_mov_b32 exec_lo, 0x00f000f0
    s_mov_b32 exec_hi, 0x00f000f0
    v_mov_b32 v8, s43
    v_mov_b32 v9, s45
    s_mov_b32 exec_lo, 0x00ff00ff
    s_mov_b32 exec_hi, 0x00ff00ff
    v_mul_f32 v9, 0x3b000000, v9
    v_mul_f32 v8, 0x3b000000, v8
    v_fma_f32 v8, -v9, v9, v8
    v_max_f32 v8, 0, v8
    v_add_f32 v8, 0x3727c5ac, v8
    v_rsq_f32 v8, v8
    v_fma_f32 v4, -v9, v6, v4
    v_fma_f32 v4, v4, v8, v7
    v_mul_f32 v5, 0xbfb8aa3b, v4
    v_exp_f32 v5, v5
    s_nop 0
    v_add_f32 v5, 1.0, v5
    v_rcp_f32 v5, v5
    s_nop 0
    v_mul_f32 v4, v4, v5
    v_cvt_pk_bf16_f32 v4, v4, v4
    ds_write_b16 v158, v4
    s_mov_b64 exec, -1
    s_waitcnt lgkmcnt(0)
    s_barrier
    ds_read_b128 v[48:51], v10 offset:7936
    ds_read_b128 v[52:55], v10 offset:8000
    s_waitcnt lgkmcnt(1)
    v_mfma_f32_16x16x32_bf16 v[128:131], v[64:67], v[48:51], 0
    v_mfma_f32_16x16x32_bf16 v[132:135], v[68:71], v[48:51], 0
    s_waitcnt lgkmcnt(0)
    v_mfma_f32_16x16x32_bf16 v[128:131], v[72:75], v[52:55], v[128:131]
    v_mfma_f32_16x16x32_bf16 v[132:135], v[76:79], v[52:55], v[132:135]
    s_mov_b32 exec_lo, 0x000f000f
    s_mov_b32 exec_hi, 0x000f000f
    s_nop 5
    v_cndmask_b32 v128, v128, v132, s[62:63]
    v_cndmask_b32 v129, v129, v133, s[62:63]
    v_cndmask_b32 v130, v130, v134, s[62:63]
    v_cndmask_b32 v131, v131, v135, s[62:63]
    v_and_or_b32 v128, v128, s34, v17
    v_and_or_b32 v130, v130, s34, v17
    buffer_store_dwordx4 v[128:131], v156, s[36:39], s98 offen sc1
    s_mov_b64 exec, -1
    s_lshr_b32 s42, s53, 1
    s_cmp_eq_u32 s42, s3
    s_cbranch_scc0 L_ffn_end
    s_and_b32 s46, s53, 1
    s_mul_i32 s42, s46, 3584
    s_lshl_b32 s43, s53, 7
    s_sub_u32 s42, s42, s43
    s_add_u32 s98, s98, s42
    v_and_b32 v7, 0x1ff, v152
    s_lshl_b32 s46, s46, 3
    s_lshl_b32 s46, 0x00ff00ff, s46
    s_mov_b32 s47, s46
    s_mov_b32 s35, 0
L_x1:
    buffer_load_dword v23, v159, s[36:39], s49 offen sc1
    s_add_u32 s35, s35, 1
    s_cmp_lt_u32 s35, 200000
    s_cbranch_scc0 L_end
    s_waitcnt vmcnt(0)
    v_xor_b32 v23, s50, v23
    v_and_b32 v8, 0xffff, v23
    v_cmp_ne_u32 vcc, 0, v8
    s_cbranch_vccnz L_x1
    s_mov_b32 s35, 0
Ltry_59:
    buffer_load_dwordx4 v[96:99], v152, s[36:39], s98 offen offset:0 sc1
    buffer_load_dwordx4 v[100:103], v152, s[36:39], s98 offen offset:1024 sc1
    buffer_load_dwordx4 v[104:107], v152, s[36:39], s98 offen offset:2048 sc1
    buffer_load_dwordx4 v[108:111], v7, s[36:39], s98 offen offset:3072 sc1
    s_add_u32 s35, s35, 1
    s_cmp_lt_u32 s35, 200000
    s_cbranch_scc0 L_end
Lchk_60:
    s_waitcnt vmcnt(3)
    v_xor_b32 v96, s31, v96
    v_xor_b32 v98, s31, v98
    v_or_b32 v9, v96, v98
    s_waitcnt vmcnt(2)
    v_xor_b32 v100, s31, v100
    v_xor_b32 v102, s31, v102
    v_or3_b32 v9, v100, v102, v9
    v_pk_add_f32 v[96:97], v[96:97], v[100:101]
    v_pk_add_f32 v[98:99], v[98:99], v[102:103]
    s_waitcnt vmcnt(1)
    v_xor_b32 v104, s31, v104
    v_xor_b32 v106, s31, v106
    v_or3_b32 v9, v104, v106, v9
    v_pk_add_f32 v[96:97], v[96:97], v[104:105]
    v_pk_add_f32 v[98:99], v[98:99], v[106:107]
    s_waitcnt vmcnt(0)
    v_xor_b32 v108, s31, v108
    v_xor_b32 v110, s31, v110
    v_or3_b32 v9, v108, v110, v9
    v_and_b32 v8, 0xff, v9
    v_cmp_ne_u32 vcc, 0, v8
    s_mov_b32 exec_hi, 0
    v_pk_add_f32 v[96:97], v[96:97], v[108:109]
    v_pk_add_f32 v[98:99], v[98:99], v[110:111]
    s_mov_b64 exec, -1
    s_cbranch_vccnz Ltry_59
    v_permlane32_swap_b32 v96, v98
    v_permlane32_swap_b32 v97, v99
    v_add_f32 v96, v96, v98
    v_add_f32 v97, v97, v99
    s_nop 1
    v_permlane16_swap_b32 v96, v97
    v_add_f32 v4, v96, v97
    s_nop 1
    v_add_f32_dpp v4, v4, v4 row_ror:8 row_mask:0xf bank_mask:0xf
    v_fma_f32 v4, v21, v4, v23
    v_cvt_pk_bf16_f32 v4, v4, v4
    s_mov_b64 exec, s[46:47]
    global_store_short v148, v4, s[24:25]
    s_cmp_eq_u32 s2, 0
    s_cbranch_scc0 L_ffn_end
    s_add_u32 s42, s30, 1
    s_mov_b64 exec, 1
    v_mov_b32 v5, s42
    v_mov_b32 v6, 0
    buffer_store_dword v5, v6, s[36:39], 0 offen sc1
L_ffn_end:
    s_endpgm
L_segb:
    s_cmp_eq_u32 s41, 3
    s_cbranch_scc1 L_segb1
    s_mov_b32 s41, 3
    s_mov_b32 s62, 0
    v_subrev_u32 v14, 8, v14
L_segb1:
    s_waitcnt vmcnt(31)
    buffer_load_dwordx4 v16, s[56:59], s44 offen nt lds
    s_add_u32 m0, m0, s49
    s_add_u32 s44, s44, s47
    s_and_b32 s44, s44, s48
    s_waitcnt vmcnt(31)
    buffer_load_dwordx4 v17, s[56:59], s44 offen nt lds
    s_add_u32 m0, m0, s49
    s_add_u32 s44, s44, s47
    s_and_b32 s44, s44, s48
    s_waitcnt vmcnt(31)
    buffer_load_dwordx4 v18, s[56:59], s44 offen nt lds
    s_add_u32 m0, m0, s49
    s_add_u32 s44, s44, s47
    s_and_b32 s44, s44, s48
    s_waitcnt vmcnt(31)
    buffer_load_dwordx4 v19, s[56:59], s44 offen nt lds
    s_add_u32 m0, m0, s49
    s_add_u32 s44, s44, s47
    s_and_b32 s44, s44, s48
    s_waitcnt vmcnt(31)
    buffer_load_dwordx4 v16, s[56:59], s44 offen nt lds
    s_add_u32 m0, m0, s49
    s_add_u32 s44, s44, s47
    s_and_b32 s44, s44, s48
    s_waitcnt vmcnt(31)
    buffer_load_dwordx4 v17, s[56:59], s44 offen nt lds
    s_add_u32 m0, m0, s49
    s_add_u32 s44, s44, s47
    s_and_b32 s44, s44, s48
    s_waitcnt vmcnt(31)
    buffer_load_dwordx4 v18, s[56:59], s44 offen nt lds
    s_add_u32 m0, m0, s49
    s_add_u32 s44, s44, s47
    s_and_b32 s44, s44, s48
    s_waitcnt vmcnt(31)
    s_mov_b64 exec, 1
    v_add_u32 v14, 8, v14
    ds_write_b32 v15, v14 offset:0
    s_mov_b64 exec, -1
    buffer_load_dwordx4 v19, s[56:59], s44 offen nt lds
    s_add_u32 m0, m0, s49
    s_add_u32 s44, s44, s47
    s_and_b32 s44, s44, s48
    s_sub_u32 s45, s45, 1
    s_cbranch_scc0 L_segb1
    s_setpc_b64 s[50:51]
L_loader2:
    s_cmp_eq_u32 s55, 0
    s_cbranch_scc0 L_ld_notwo
    s_mov_b32 s56, s12
    s_mov_b32 s57, s13
    s_mov_b32 s58, 4194304
    s_mov_b32 s59, 0x20000
L_pad10:
    s_cbranch_execz L_pad11
    s_lshl_b32 s42, s53, 17
    s_lshl_b32 s43, s54, 8
    s_add_u32 s44, s42, s43
    s_mov_b32 m0, 16384
    s_mov_b32 s35, 0
Lsp_62:
    ds_read_b32 v9, v15 offset:12
    s_add_u32 s35, s35, 1
    s_cmp_lt_u32 s35, 2000000
    s_cbranch_scc0 L_end
    s_waitcnt lgkmcnt(0)
    v_readfirstlane_b32 s42, v9
    s_cmp_ge_i32 s42, 4
    s_cbranch_scc0 Lsp_62
Lok_61:
    s_cmp_eq_u32 s41, 3
    s_cselect_b32 s42, 0, 8
    v_subrev_u32 v14, s42, v14
    s_movk_i32 s47, 0x1000
    s_mov_b32 s45, 2
Lseg_63:
    buffer_load_dwordx4 v24, s[56:59], s44 offen nt lds
    s_add_u32 m0, m0, s49
    s_add_u32 s44, s44, s47
    buffer_load_dwordx4 v25, s[56:59], s44 offen nt lds
    s_add_u32 m0, m0, s49
    s_add_u32 s44, s44, s47
    buffer_load_dwordx4 v24, s[56:59], s44 offen nt lds
    s_add_u32 m0, m0, s49
    s_add_u32 s44, s44, s47
    buffer_load_dwordx4 v25, s[56:59], s44 offen nt lds
    s_add_u32 m0, m0, s49
    s_add_u32 s44, s44, s47
    buffer_load_dwordx4 v24, s[56:59], s44 offen nt lds
    s_add_u32 m0, m0, s49
    s_add_u32 s44, s44, s47
    buffer_load_dwordx4 v25, s[56:59], s44 offen nt lds
    s_add_u32 m0, m0, s49
    s_add_u32 s44, s44, s47
    buffer_load_dwordx4 v24, s[56:59], s44 offen nt lds
    s_add_u32 m0, m0, s49
    s_add_u32 s44, s44, s47
    buffer_load_dwordx4 v25, s[56:59], s44 offen nt lds
    s_add_u32 m0, m0, s49
    s_add_u32 s44, s44, s47
    s_sub_u32 s45, s45, 1
    s_cbranch_scc0 Lseg_63
    s_waitcnt vmcnt(48)
    s_mov_b64 exec, 1
    v_add_u32 v14, 8, v14
    ds_write_b32 v15, v14 offset:0
    s_mov_b64 exec, -1
    buffer_load_dwordx4 v24, s[56:59], s44 offen nt lds
    s_add_u32 m0, m0, s49
    s_add_u32 s44, s44, s47
    buffer_load_dwordx4 v25, s[56:59], s44 offen nt lds
    s_add_u32 m0, m0, s49
    s_add_u32 s44, s44, s47
    buffer_load_dwordx4 v24, s[56:59], s44 offen nt lds
    s_add_u32 m0, m0, s49
    s_add_u32 s44, s44, s47
    buffer_load_dwordx4 v25, s[56:59], s44 offen nt lds
    s_add_u32 m0, m0, s49
    s_add_u32 s44, s44, s47
    buffer_load_dwordx4 v24, s[56:59], s44 offen nt lds
    s_add_u32 m0, m0, s49
    s_add_u32 s44, s44, s47
    buffer_load_dwordx4 v25, s[56:59], s44 offen nt lds
    s_add_u32 m0, m0, s49
    s_add_u32 s44, s44, s47
    buffer_load_dwordx4 v24, s[56:59], s44 offen nt lds
    s_add_u32 m0, m0, s49
    s_add_u32 s44, s44, s47
    buffer_load_dwordx4 v25, s[56:59], s44 offen nt lds
    s_add_u32 m0, m0, s49
    s_add_u32 s44, s44, s47
    s_waitcnt vmcnt(48)
    s_mov_b64 exec, 1
    v_add_u32 v14, 8, v14
    ds_write_b32 v15, v14 offset:0
    s_mov_b64 exec, -1
    s_waitcnt vmcnt(40)
    s_mov_b64 exec, 1
    v_add_u32 v14, 8, v14
    ds_write_b32 v15, v14 offset:0
    s_mov_b64 exec, -1
    s_waitcnt vmcnt(32)
    s_mov_b64 exec, 1
    v_add_u32 v14, 8, v14
    ds_write_b32 v15, v14 offset:0
    s_mov_b64 exec, -1
    s_waitcnt vmcnt(0)
    v_mov_b32 v14, 184
    s_mov_b64 exec, 1
    v_add_u32 v14, 8, v14
    ds_write_b32 v15, v14 offset:0
    s_mov_b64 exec, -1
    s_endpgm
L_ld_notwo:
    s_cmp_eq_u32 s41, 3
    s_cselect_b32 s42, 0, 8
    v_subrev_u32 v14, s42, v14
    s_waitcnt vmcnt(24)
    s_mov_b64 exec, 1
    v_add_u32 v14, 8, v14
    ds_write_b32 v15, v14 offset:0
    s_mov_b64 exec, -1
    s_waitcnt vmcnt(16)
    s_mov_b64 exec, 1
    v_add_u32 v14, 8, v14
    ds_write_b32 v15, v14 offset:0
    s_mov_b64 exec, -1
    s_waitcnt vmcnt(8)
    s_mov_b64 exec, 1
    v_add_u32 v14, 8, v14
    ds_write_b32 v15, v14 offset:0
    s_mov_b64 exec, -1
    s_waitcnt vmcnt(0)
    s_mov_b64 exec, 1
    v_add_u32 v14, 8, v14
    ds_write_b32 v15, v14 offset:0
    s_mov_b64 exec, -1
    s_cmp_eq_u32 s55, 1
    s_cbranch_scc0 L_ld_end
    v_mul_u32_u24 v26, 3584, v4
    v_add_u32 v26, v26, v5
    s_mov_b32 s56, s16
    s_mov_b32 s57, s17
    s_mov_b32 s58, 1835008
    s_mov_b32 s59, 0x20000
    s_movk_i32 s47, 0x1000
    s_movk_i32 s46, 28672
    s_mul_i32 s42, s54, 458752
    s_lshl_b32 s43, s53, 7
    s_add_u32 s44, s42, s43
    s_mov_b32 m0, 16384
    s_load_dword s30, s[28:29], 0
    v_and_b32 v8, 31, v0
    v_lshlrev_b32 v8, 7, v8
    s_lshl_b32 s42, s32, 16
    s_add_u32 s42, s42, 1048576
    v_add_u32 v8, s42, v8
    s_mov_b32 s35, 0
Lsp_66:
    ds_read_b32 v9, v15 offset:36
    s_add_u32 s35, s35, 1
    s_cmp_lt_u32 s35, 2000000
    s_cbranch_scc0 L_end
    s_waitcnt lgkmcnt(0)
    v_readfirstlane_b32 s42, v9
    s_cmp_ge_i32 s42, 4
    s_cbranch_scc0 Lsp_66
Lok_65:
    s_add_u32 s31, s30, 1
    s_and_b32 s31, s31, 0xff
    s_mov_b32 s35, 0
L_ld_grp:
    global_load_ubyte v9, v8, s[28:29] sc1
    s_add_u32 s35, s35, 1
    s_cmp_lt_u32 s35, 64
    s_cbranch_scc0 L_ld_go
    s_waitcnt vmcnt(0)
    v_cmp_eq_u32 vcc, s31, v9
    s_bcnt1_i32_b64 s42, vcc
    s_cmp_ge_u32 s42, 56
    s_cbranch_scc0 L_ld_grp
L_ld_go:
    s_mov_b32 s45, 1
Lseg_67:
    buffer_load_dwordx4 v26, s[56:59], s44 offen nt lds
    s_add_u32 m0, m0, s49
    s_add_u32 s44, s44, s46
    buffer_load_dwordx4 v26, s[56:59], s44 offen nt lds
    s_add_u32 m0, m0, s49
    s_add_u32 s44, s44, s46
    buffer_load_dwordx4 v26, s[56:59], s44 offen nt lds
    s_add_u32 m0, m0, s49
    s_add_u32 s44, s44, s46
    buffer_load_dwordx4 v26, s[56:59], s44 offen nt lds
    s_add_u32 m0, m0, s49
    s_add_u32 s44, s44, s46
    buffer_load_dwordx4 v26, s[56:59], s44 offen nt lds
    s_add_u32 m0, m0, s49
    s_add_u32 s44, s44, s46
    buffer_load_dwordx4 v26, s[56:59], s44 offen nt lds
    s_add_u32 m0, m0, s49
    s_add_u32 s44, s44, s46
    buffer_load_dwordx4 v26, s[56:59], s44 offen nt lds
    s_add_u32 m0, m0, s49
    s_add_u32 s44, s44, s46
    buffer_load_dwordx4 v26, s[56:59], s44 offen nt lds
    s_add_u32 m0, m0, s49
    s_add_u32 s44, s44, s46
    s_sub_u32 s45, s45, 1
    s_cbranch_scc0 Lseg_67
    s_waitcnt vmcnt(0)
    v_mov_b32 v14, 184
    s_mov_b64 exec, 1
    v_add_u32 v14, 8, v14
    ds_write_b32 v15, v14 offset:0
    s_mov_b64 exec, -1
L_ld_end:
    s_endpgm
L_pad11:
    s_branch L_warmed
L_aux:
    s_waitcnt vmcnt(0)
    s_mov_b64 exec, 0
    s_branch L_pad0
L_warmed:
    s_mov_b64 exec, -1
    v_and_b32 v12, 7, v0
    v_lshlrev_b32 v12, 5, v12
    s_lshl_b32 s48, s53, 2
    s_add_u32 s48, s48, s54
    s_lshl_b32 s48, s48, 8
    s_add_u32 s48, s48, 819200
    s_cmp_eq_u32 s55, 0
    s_cselect_b32 s48, s48, 0x400000
    buffer_load_dwordx4 v[32:35], v12, s[36:39], s48 offen sc1
    v_and_b32 v3, 3, v0
    v_lshlrev_b32 v3, 5, v3
    v_bfe_u32 v4, v0, 2, 2
    v_lshrrev_b32 v5, 4, v0
    v_lshl_add_u32 v10, v4, 12, v3
    v_lshl_add_u32 v10, v5, 14, v10
    s_lshl_b32 s46, s32, 9
    s_and_b32 s43, s33, 3
    s_lshl_b32 s43, s43, 3
    s_add_u32 s46, s46, s43
    s_bfe_u32 s43, s33, 0x20002
    s_lshl_b32 s43, s43, 1
    s_add_u32 s46, s46, s43
    s_lshr_b32 s43, s33, 4
    s_add_u32 s46, s46, s43
    s_lshl_b32 s46, s46, 7
    s_add_u32 s46, s46, 1048576
    s_mov_b32 s35, 0
Lsp_69:
    ds_read_b32 v9, v15 offset:0
    s_add_u32 s35, s35, 1
    s_cmp_lt_u32 s35, 2000000
    s_cbranch_scc0 L_end
    s_waitcnt lgkmcnt(0)
    v_readfirstlane_b32 s42, v9
    s_cmp_ge_i32 s42, 128
    s_cbranch_scc0 Lsp_69
Lok_68:
    buffer_load_dwordx4 v[24:27], v10, s[36:39], s46 offen sc1
    s_endpgm
Lsp_24_h:
    s_mov_b32 exec_lo, 0x00030003
    s_mov_b32 exec_hi, 0x00030003
    buffer_store_dwordx4 v[140:143], v159, s[36:39], s51 offen sc1
    s_mov_b64 exec, -1
    s_branch Lsp_24_n
Lst_27:
    buffer_store_dwordx2 v[132:133], v147, s[36:39], s44 offen sc1
    s_branch Lst_28
Lst_29:
    buffer_store_dwordx2 v[132:133], v147, s[36:39], s44 offen sc1
    s_branch Lst_30
Lst_39:
    buffer_store_dwordx4 v[128:131], v154, s[36:39], s96 offen sc1
    s_branch Lst_40
Lst_53:
    buffer_store_dwordx4 v[128:131], v155, s[36:39], s97 offen sc1
    s_branch Lst_54
Lst_55:
    buffer_store_dword v23, v159, s[36:39], s49 offen sc1
    s_branch Lst_56
L_end:
    s_endpgm
L_codeend:
.section .rodata,"a"
.p2align 6
.amdhsa_kernel adaLN_cond__sliding_block_cached__dense_activation_silu__decode_kernel
  .amdhsa_next_free_vgpr 216
  .amdhsa_next_free_sgpr 102
  .amdhsa_accum_offset 216
  .amdhsa_group_segment_fixed_size 0
  .amdhsa_kernarg_size 104
  .amdhsa_user_sgpr_count 2
  .amdhsa_user_sgpr_kernarg_segment_ptr 1
  .amdhsa_system_sgpr_workgroup_id_x 1
  .amdhsa_float_denorm_mode_32 3
.end_amdhsa_kernel
```
